```python
import torch

def _softmax(x, axis=-1):
    return torch.softmax(x, dim=axis)
def _gelu(x):
    return torch.nn.functional.gelu(x, approximate="tanh")
def _silu(x):
    return torch.nn.functional.silu(x)
def _sigmoid(x):
    return torch.sigmoid(x)
def _layernorm(x, axis=-1, eps=1e-5):
    m = x.mean(dim=axis, keepdim=True)
    v = x.var(dim=axis, keepdim=True, unbiased=False)
    return (x - m) / torch.sqrt(v + eps)
def _scatter_add(tgt, idx, src, axis=0):
    return tgt.clone().index_add_(axis, idx, src)
def _segment_sum(src, seg, n):
    out = torch.zeros((n,) + src.shape[1:], dtype=src.dtype)
    return out.index_add_(0, seg, src)
def _pad(x, pw):
    flat = tuple(v for pair in reversed(pw) for v in pair)
    return torch.nn.functional.pad(x, flat)

kernel_name = 'recurrent_scan__gqa_block_cached__dense_activation_relu__decode'

def setup_inputs():

    _w = (lambda a: (lambda t: t.to(torch.bfloat16) if t.is_floating_point() else t)(torch.as_tensor(a)))
    def _A_setup():
        B, Sq, D = 2, 1, 512
        Hq, Hkv, Sk, Dh = 32, 8, 32768, 128
        assert Hq % Hkv == 0, (Hq, Hkv)
        return {
            "x": _w((lambda *s: torch.randn(*s, dtype=torch.bfloat16) * 0.05)(B, Sq, D)),
            "k_cache": _w((lambda *s: torch.randn(*s, dtype=torch.bfloat16) * 0.8)(B, Hkv, Sk, Dh)),
            "v_cache": _w((lambda *s: torch.randn(*s, dtype=torch.bfloat16) * 0.8)(B, Hkv, Sk, Dh)),
            "wq": _w((lambda *s: torch.randn(*s, dtype=torch.bfloat16) * 0.8)(D, Hq * Dh) * (D ** -0.5)),
            "wo": _w((lambda *s: torch.randn(*s, dtype=torch.bfloat16) * 0.8)(Hq * Dh, D) * ((Hq * Dh) ** -0.5)),
        }
    _A_in = _A_setup()

    def _B_setup():
        B, S, D, Dff = 2, 1, 512, 1792
        return {
            "x": _w((lambda *s: torch.randn(*s, dtype=torch.bfloat16) * 0.05)(B, S, D)),
            "w1": _w((lambda *s: torch.randn(*s, dtype=torch.bfloat16) * 0.2)(D, Dff)),
            "w2": _w((lambda *s: torch.randn(*s, dtype=torch.bfloat16) * 0.2)(Dff, D)),
        }
    _B_in = _B_setup()

    return {
        "A_x": _A_in["x"],
        "A_k_cache": _A_in["k_cache"],
        "A_v_cache": _A_in["v_cache"],
        "A_wq": _A_in["wq"],
        "A_wo": _A_in["wo"],
        "B_x": _B_in["x"],
        "B_w1": _B_in["w1"],
        "B_w2": _B_in["w2"],
    }

def reference(A_x, A_k_cache, A_v_cache, A_wq, A_wo, B_x, B_w1, B_w2):
    def _A_ref(x, k_cache, v_cache, wq, wo):
        B, Sq, D = x.shape
        Hq, Dh = 32, 128
        Hkv = k_cache.shape[1]
        rep = Hq // Hkv
        q = (lambda x, *d: x.permute(*d))((x @ wq).reshape(B, Sq, Hq, Dh), 0, 2, 1, 3)
        k = (lambda x, n, axis: torch.repeat_interleave(x, n, dim=axis))(k_cache, rep, axis=1)
        v = (lambda x, n, axis: torch.repeat_interleave(x, n, dim=axis))(v_cache, rep, axis=1)
        scores = torch.einsum("bhqd,bhkd->bhqk", q, k) * (Dh ** -0.5)
        p = _softmax(scores, axis=-1)
        o = torch.einsum("bhqk,bhkd->bhqd", p, v)
        return (lambda x, *d: x.permute(*d))(o, 0, 2, 1, 3).reshape(B, Sq, Hq * Dh) @ wo

    def _B_ref(x, w1, w2):
        h = torch.einsum("bsd,df->bsf", x, w1)
        zero = torch.zeros_like(h)
        h = torch.maximum(h, zero)
        return torch.einsum("bsf,fd->bsd", h, w2)

    x = A_x
    xn = _layernorm(x, axis=-1)
    s = _A_ref(xn, A_k_cache, A_v_cache, A_wq, A_wo)
    g = _silu(_B_ref(xn, B_w1, B_w2))
    return x + s * g
```

```asm
; @launch grid=(256,1,1) block=(512,1,1) lds=61952
.amdgcn_target "amdgcn-amd-amdhsa--gfx950"
.text
.globl recurrent_scan__gqa_block_cached__dense_activation_relu__decode_kernel
.p2align 8
.type recurrent_scan__gqa_block_cached__dense_activation_relu__decode_kernel,@function
recurrent_scan__gqa_block_cached__dense_activation_relu__decode_kernel:
  s_cmp_ge_u32 s2, 256
  s_cbranch_scc1 K_END
  s_load_dwordx16 s[4:19], s[0:1], 0
  s_load_dwordx2 s[24:25], s[0:1], 80
  v_and_b32 v1, 63, v0
  v_lshrrev_b32 v2, 6, v0
  v_and_b32 v3, 15, v1
  v_lshrrev_b32 v4, 4, v1
  v_mov_b32 v248, 0
  v_readfirstlane_b32 s3, v2
  s_and_b32 s86, s2, 7
  s_lshr_b32 s87, s2, 3
  s_and_b32 s83, s87, 7
  s_lshl_b32 s84, s86, 5
  s_add_u32 s84, s84, s87
  s_lshr_b32 s85, s87, 3
  s_lshl_b32 s85, s85, 6
  s_lshl_b32 s74, s86, 3
  s_add_u32 s85, s85, s74
  s_add_u32 s85, s85, s83
  s_lshr_b32 s88, s87, 4
  s_and_b32 s89, s87, 15
  s_and_b32 s90, s2, 7
  s_lshr_b32 s91, s87, 3
  s_lshl_b32 s74, s86, 2
  s_add_u32 s91, s91, s74
  s_lshr_b32 s88, s2, 7
  s_lshr_b32 s86, s2, 4
  s_and_b32 s86, s86, 7
  s_and_b32 s89, s2, 15
  s_and_b32 s75, s2, 63
  s_lshr_b32 s76, s2, 6
  s_lshr_b32 s74, s75, 2
  s_lshr_b32 s88, s74, 3
  s_and_b32 s86, s74, 7
  s_and_b32 s77, s75, 3
  s_lshl_b32 s89, s77, 2
  s_add_u32 s89, s89, s76
  s_lshl_b32 s93, s88, 3
  s_add_u32 s93, s93, s86
  s_mul_i32 s93, s93, 4
  s_and_b32 s74, s3, 3
  s_add_u32 s93, s93, s74
  s_lshl_b32 s93, s93, 8
  s_add_u32 s93, s93, 3145728
  s_mul_i32 s92, s74, 0
  s_add_u32 s92, s92, 1024
  s_mul_i32 s94, s89, 64
  s_mov_b32 s95, 0
  s_lshr_b32 s94, s89, 2
  s_lshl_b32 s94, s94, 8
  s_and_b32 s76, s89, 3
  s_lshl_b32 s76, s76, 2
  s_add_u32 s94, s94, s76
  s_and_b32 s75, s2, 63
  s_mul_i32 s95, s75, 1
  s_lshl_b32 s74, s88, 3
  s_add_u32 s74, s74, s86
  s_lshl_b32 s74, s74, 23
  s_mov_b32 s68, 0x3e0293ee
  s_mov_b32 s69, 0x05040100
  s_mov_b32 s70, 0x07060302
  s_lshl_b32 s75, s3, 1
  s_sub_u32 s72, s75, 2
  s_sub_u32 s73, s75, 1
  s_lshr_b32 s75, s3, 2
  s_add_u32 s75, s75, s95
  s_and_b32 s75, s75, 15
  s_lshl_b32 s75, s75, 4
  s_and_b32 s76, s3, 3
  s_add_u32 s75, s75, s76
  s_add_u32 s72, s75, s94
  v_and_b32 v5, 3, v3
  v_lshrrev_b32 v6, 2, v3
  v_lshl_add_u32 v5, v5, 2, v6
  v_lshlrev_b32 v5, 8, v5
  v_lshl_add_u32 v242, v4, 4, v5
  v_lshlrev_b32 v243, 4, v1
  s_waitcnt lgkmcnt(0)
  s_mov_b32 s28, s4
  s_and_b32 s29, s5, 0xffff
  s_mov_b32 s30, 2048
  s_mov_b32 s31, 0x00020000
  s_mov_b32 s40, s10
  s_and_b32 s41, s11, 0xffff
  s_mov_b32 s42, 4194304
  s_mov_b32 s43, 0x00020000
  s_mov_b32 s20, s24
  s_and_b32 s21, s25, 0xffff
  s_mov_b32 s22, 536870912
  s_mov_b32 s23, 0x00020000
  s_add_u32 s60, s6, s74
  s_addc_u32 s61, s7, 0
  s_and_b32 s61, s61, 0xffff
  s_mov_b32 s62, 8388608
  s_mov_b32 s63, 0x00020000
  s_add_u32 s64, s8, s74
  s_addc_u32 s65, s9, 0
  s_and_b32 s65, s65, 0xffff
  s_mov_b32 s66, s62
  s_mov_b32 s67, 0x00020000
  s_movk_i32 s71, 4096
  s_and_b32 s75, s2, 0x78
  s_or_b32 s75, s75, s3
  s_cmp_lg_u32 s75, 0
  s_cbranch_scc1 K_NOINIT
  s_lshr_b32 s75, s2, 7
  s_lshl_b32 s75, s75, 3
  s_and_b32 s76, s2, 7
  s_add_u32 s75, s75, s76
  s_mul_i32 s75, s75, 1024
  s_add_u32 s75, s75, 3145728
  v_mov_b32 v5, 0
  v_lshlrev_b32 v6, 8, v1
  s_mov_b64 exec, 15
  buffer_store_dword v5, v6, s[20:23], s75 offen sc1
  s_mov_b64 exec, -1
K_NOINIT:
  v_lshrrev_b32 v12, 3, v0
  v_and_b32 v13, 7, v0
  s_lshl_b32 s75, s72, 13
  v_add_u32 v228, s75, v242
  v_add_u32 v229, s75, v243
  s_cmp_ge_u32 s3, 4
  s_cbranch_scc1 K_FLOOD
  v_lshlrev_b32 v5, 4, v1
  buffer_load_dwordx4 v[204:207], v5, s[28:31], 0 offen
  buffer_load_dwordx4 v[208:211], v5, s[28:31], 0 offen offset:1024
  v_lshrrev_b32 v6, 2, v0
  v_and_b32 v7, 3, v0
  v_lshlrev_b32 v8, 13, v6
  v_lshl_add_u32 v8, v7, 3, v8
  s_lshl_b32 s75, s84, 5
  v_add_u32 v8, s75, v8
  buffer_load_dwordx2 v[212:213], v8, s[40:43], 0 offen
  v_add_u32 v8, 0x80000, v8
  buffer_load_dwordx2 v[214:215], v8, s[40:43], 0 offen
  v_add_u32 v8, 0x80000, v8
  buffer_load_dwordx2 v[216:217], v8, s[40:43], 0 offen
  v_add_u32 v8, 0x80000, v8
  buffer_load_dwordx2 v[218:219], v8, s[40:43], 0 offen
  v_add_u32 v8, 0x80000, v8
  buffer_load_dwordx2 v[220:221], v8, s[40:43], 0 offen
  v_add_u32 v8, 0x80000, v8
  buffer_load_dwordx2 v[222:223], v8, s[40:43], 0 offen
  v_add_u32 v8, 0x80000, v8
  buffer_load_dwordx2 v[224:225], v8, s[40:43], 0 offen
  v_add_u32 v8, 0x80000, v8
  buffer_load_dwordx2 v[226:227], v8, s[40:43], 0 offen
  s_cmp_lg_u32 s3, 0
  s_cbranch_scc1 K_NOLI
  v_mov_b32 v8, 8
  v_mov_b32 v9, 0
  v_mov_b32 v10, 8
  v_mov_b32 v11, 8
  v_mov_b32 v5, 7168
  s_mov_b64 exec, 1
  ds_write_b128 v5, v[8:11]
  v_mov_b32 v8, 0
  v_mov_b32 v10, 0
  v_mov_b32 v11, 0
  ds_write_b128 v5, v[8:11] offset:16
  ds_write_b128 v5, v[8:11] offset:32
  s_mov_b64 exec, -1
  s_waitcnt lgkmcnt(0)
K_NOLI:
  s_barrier
  s_mov_b32 s75, 2162688
  s_load_dword s26, s[24:25], s75
  v_lshrrev_b32 v230, 3, v1
  v_lshlrev_b32 v230, 14, v230
  v_and_b32 v7, 7, v1
  v_lshl_add_u32 v230, v7, 3, v230
  s_lshl_b32 s75, s84, 6
  s_add_u32 s75, s75, 2097152
  v_add_u32 v230, s75, v230
  s_mul_i32 s75, s3, 192
  v_lshlrev_b32 v231, 4, v1
  v_add_u32 v231, s75, v231
  s_waitcnt vmcnt(8)
  v_lshlrev_b32 v144, 16, v204
  v_and_b32 v145, 0xffff0000, v204
  v_lshlrev_b32 v146, 16, v205
  v_and_b32 v147, 0xffff0000, v205
  v_lshlrev_b32 v148, 16, v206
  v_and_b32 v149, 0xffff0000, v206
  v_lshlrev_b32 v150, 16, v207
  v_and_b32 v151, 0xffff0000, v207
  v_lshlrev_b32 v152, 16, v208
  v_and_b32 v153, 0xffff0000, v208
  v_lshlrev_b32 v154, 16, v209
  v_and_b32 v155, 0xffff0000, v209
  v_lshlrev_b32 v156, 16, v210
  v_and_b32 v157, 0xffff0000, v210
  v_lshlrev_b32 v158, 16, v211
  v_and_b32 v159, 0xffff0000, v211
  v_pk_add_f32 v[160:161], v[144:145], v[146:147]
  v_pk_add_f32 v[162:163], v[148:149], v[150:151]
  v_pk_add_f32 v[164:165], v[152:153], v[154:155]
  v_pk_add_f32 v[166:167], v[156:157], v[158:159]
  v_pk_add_f32 v[160:161], v[160:161], v[162:163]
  v_pk_add_f32 v[164:165], v[164:165], v[166:167]
  v_add_f32 v160, v160, v161
  v_add_f32 v161, v164, v165
  s_nop 1
  v_add_f32_dpp v160, v160, v160 quad_perm:[1,0,3,2] row_mask:0xf bank_mask:0xf
  v_add_f32_dpp v161, v161, v161 quad_perm:[1,0,3,2] row_mask:0xf bank_mask:0xf
  s_nop 1
  v_add_f32_dpp v160, v160, v160 quad_perm:[2,3,0,1] row_mask:0xf bank_mask:0xf
  v_add_f32_dpp v161, v161, v161 quad_perm:[2,3,0,1] row_mask:0xf bank_mask:0xf
  s_nop 1
  v_add_f32_dpp v160, v160, v160 row_half_mirror row_mask:0xf bank_mask:0xf
  v_add_f32_dpp v161, v161, v161 row_half_mirror row_mask:0xf bank_mask:0xf
  s_nop 1
  v_add_f32_dpp v160, v160, v160 row_mirror row_mask:0xf bank_mask:0xf
  v_add_f32_dpp v161, v161, v161 row_mirror row_mask:0xf bank_mask:0xf
  v_mov_b32 v162, v160
  v_mov_b32 v163, v161
  s_nop 1
  v_permlane16_swap_b32 v160, v162
  v_permlane16_swap_b32 v161, v163
  s_nop 1
  v_add_f32 v160, v160, v162
  v_add_f32 v161, v161, v163
  v_mov_b32 v162, v160
  v_mov_b32 v163, v161
  s_nop 1
  v_permlane32_swap_b32 v160, v162
  v_permlane32_swap_b32 v161, v163
  s_nop 1
  v_add_f32 v160, v160, v162
  v_add_f32 v161, v161, v163
  v_mul_f32 v160, 0x3b000000, v160
  v_mul_f32 v161, 0x3b000000, v161
  v_pk_add_f32 v[168:169], v[144:145], v[160:161] op_sel_hi:[1,0] neg_lo:[0,1] neg_hi:[0,1]
  v_pk_add_f32 v[170:171], v[146:147], v[160:161] op_sel_hi:[1,0] neg_lo:[0,1] neg_hi:[0,1]
  v_pk_add_f32 v[172:173], v[148:149], v[160:161] op_sel_hi:[1,0] neg_lo:[0,1] neg_hi:[0,1]
  v_pk_add_f32 v[174:175], v[150:151], v[160:161] op_sel_hi:[1,0] neg_lo:[0,1] neg_hi:[0,1]
  v_pk_add_f32 v[176:177], v[152:153], v[160:161] op_sel:[0,1] op_sel_hi:[1,1] neg_lo:[0,1] neg_hi:[0,1]
  v_pk_add_f32 v[178:179], v[154:155], v[160:161] op_sel:[0,1] op_sel_hi:[1,1] neg_lo:[0,1] neg_hi:[0,1]
  v_pk_add_f32 v[180:181], v[156:157], v[160:161] op_sel:[0,1] op_sel_hi:[1,1] neg_lo:[0,1] neg_hi:[0,1]
  v_pk_add_f32 v[182:183], v[158:159], v[160:161] op_sel:[0,1] op_sel_hi:[1,1] neg_lo:[0,1] neg_hi:[0,1]
  v_pk_mul_f32 v[164:165], v[168:169], v[168:169]
  v_pk_mul_f32 v[166:167], v[176:177], v[176:177]
  v_pk_fma_f32 v[164:165], v[170:171], v[170:171], v[164:165]
  v_pk_fma_f32 v[166:167], v[178:179], v[178:179], v[166:167]
  v_pk_fma_f32 v[164:165], v[172:173], v[172:173], v[164:165]
  v_pk_fma_f32 v[166:167], v[180:181], v[180:181], v[166:167]
  v_pk_fma_f32 v[164:165], v[174:175], v[174:175], v[164:165]
  v_pk_fma_f32 v[166:167], v[182:183], v[182:183], v[166:167]
  v_add_f32 v164, v164, v165
  v_add_f32 v165, v166, v167
  s_nop 1
  v_add_f32_dpp v164, v164, v164 quad_perm:[1,0,3,2] row_mask:0xf bank_mask:0xf
  v_add_f32_dpp v165, v165, v165 quad_perm:[1,0,3,2] row_mask:0xf bank_mask:0xf
  s_nop 1
  v_add_f32_dpp v164, v164, v164 quad_perm:[2,3,0,1] row_mask:0xf bank_mask:0xf
  v_add_f32_dpp v165, v165, v165 quad_perm:[2,3,0,1] row_mask:0xf bank_mask:0xf
  s_nop 1
  v_add_f32_dpp v164, v164, v164 row_half_mirror row_mask:0xf bank_mask:0xf
  v_add_f32_dpp v165, v165, v165 row_half_mirror row_mask:0xf bank_mask:0xf
  s_nop 1
  v_add_f32_dpp v164, v164, v164 row_mirror row_mask:0xf bank_mask:0xf
  v_add_f32_dpp v165, v165, v165 row_mirror row_mask:0xf bank_mask:0xf
  v_mov_b32 v162, v164
  v_mov_b32 v163, v165
  s_nop 1
  v_permlane16_swap_b32 v164, v162
  v_permlane16_swap_b32 v165, v163
  s_nop 1
  v_add_f32 v164, v164, v162
  v_add_f32 v165, v165, v163
  v_mov_b32 v162, v164
  v_mov_b32 v163, v165
  s_nop 1
  v_permlane32_swap_b32 v164, v162
  v_permlane32_swap_b32 v165, v163
  s_nop 1
  v_add_f32 v164, v164, v162
  v_add_f32 v165, v165, v163
  v_mul_f32 v164, 0x3b000000, v164
  v_mul_f32 v165, 0x3b000000, v165
  v_cvt_pk_bf16_f32 v164, v164, v164
  v_lshlrev_b32 v164, 16, v164
  v_add_f32 v164, 0x3727c5ac, v164
  v_cvt_pk_bf16_f32 v164, v164, v164
  v_lshlrev_b32 v164, 16, v164
  v_sqrt_f32 v164, v164
  s_nop 0
  v_cvt_pk_bf16_f32 v164, v164, v164
  v_lshlrev_b32 v164, 16, v164
  v_rcp_f32 v164, v164
  v_cvt_pk_bf16_f32 v160, v160, v160
  v_lshlrev_b32 v160, 16, v160
  v_cvt_pk_bf16_f32 v165, v165, v165
  v_lshlrev_b32 v165, 16, v165
  v_add_f32 v165, 0x3727c5ac, v165
  v_cvt_pk_bf16_f32 v165, v165, v165
  v_lshlrev_b32 v165, 16, v165
  v_sqrt_f32 v165, v165
  s_nop 0
  v_cvt_pk_bf16_f32 v165, v165, v165
  v_lshlrev_b32 v165, 16, v165
  v_rcp_f32 v165, v165
  v_cvt_pk_bf16_f32 v161, v161, v161
  v_lshlrev_b32 v161, 16, v161
  v_pk_add_f32 v[144:145], v[144:145], v[160:161] op_sel_hi:[1,0] neg_lo:[0,1] neg_hi:[0,1]
  v_pk_add_f32 v[146:147], v[146:147], v[160:161] op_sel_hi:[1,0] neg_lo:[0,1] neg_hi:[0,1]
  v_pk_add_f32 v[148:149], v[148:149], v[160:161] op_sel_hi:[1,0] neg_lo:[0,1] neg_hi:[0,1]
  v_pk_add_f32 v[150:151], v[150:151], v[160:161] op_sel_hi:[1,0] neg_lo:[0,1] neg_hi:[0,1]
  v_cvt_pk_bf16_f32 v168, v144, v145
  v_cvt_pk_bf16_f32 v169, v146, v147
  v_cvt_pk_bf16_f32 v170, v148, v149
  v_cvt_pk_bf16_f32 v171, v150, v151
  v_lshlrev_b32 v144, 16, v168
  v_and_b32 v145, 0xffff0000, v168
  v_lshlrev_b32 v146, 16, v169
  v_and_b32 v147, 0xffff0000, v169
  v_lshlrev_b32 v148, 16, v170
  v_and_b32 v149, 0xffff0000, v170
  v_lshlrev_b32 v150, 16, v171
  v_and_b32 v151, 0xffff0000, v171
  v_pk_mul_f32 v[144:145], v[144:145], v[164:165] op_sel_hi:[1,0]
  v_pk_mul_f32 v[146:147], v[146:147], v[164:165] op_sel_hi:[1,0]
  v_pk_mul_f32 v[148:149], v[148:149], v[164:165] op_sel_hi:[1,0]
  v_pk_mul_f32 v[150:151], v[150:151], v[164:165] op_sel_hi:[1,0]
  v_cvt_pk_bf16_f32 v168, v144, v145
  v_cvt_pk_bf16_f32 v169, v146, v147
  v_cvt_pk_bf16_f32 v170, v148, v149
  v_cvt_pk_bf16_f32 v171, v150, v151
  v_lshlrev_b32 v144, 16, v168
  v_and_b32 v145, 0xffff0000, v168
  v_lshlrev_b32 v146, 16, v169
  v_and_b32 v147, 0xffff0000, v169
  v_lshlrev_b32 v148, 16, v170
  v_and_b32 v149, 0xffff0000, v170
  v_lshlrev_b32 v150, 16, v171
  v_and_b32 v151, 0xffff0000, v171
  v_pk_add_f32 v[152:153], v[152:153], v[160:161] op_sel:[0,1] op_sel_hi:[1,1] neg_lo:[0,1] neg_hi:[0,1]
  v_pk_add_f32 v[154:155], v[154:155], v[160:161] op_sel:[0,1] op_sel_hi:[1,1] neg_lo:[0,1] neg_hi:[0,1]
  v_pk_add_f32 v[156:157], v[156:157], v[160:161] op_sel:[0,1] op_sel_hi:[1,1] neg_lo:[0,1] neg_hi:[0,1]
  v_pk_add_f32 v[158:159], v[158:159], v[160:161] op_sel:[0,1] op_sel_hi:[1,1] neg_lo:[0,1] neg_hi:[0,1]
  v_cvt_pk_bf16_f32 v168, v152, v153
  v_cvt_pk_bf16_f32 v169, v154, v155
  v_cvt_pk_bf16_f32 v170, v156, v157
  v_cvt_pk_bf16_f32 v171, v158, v159
  v_lshlrev_b32 v152, 16, v168
  v_and_b32 v153, 0xffff0000, v168
  v_lshlrev_b32 v154, 16, v169
  v_and_b32 v155, 0xffff0000, v169
  v_lshlrev_b32 v156, 16, v170
  v_and_b32 v157, 0xffff0000, v170
  v_lshlrev_b32 v158, 16, v171
  v_and_b32 v159, 0xffff0000, v171
  v_pk_mul_f32 v[152:153], v[152:153], v[164:165] op_sel:[0,1] op_sel_hi:[1,1]
  v_pk_mul_f32 v[154:155], v[154:155], v[164:165] op_sel:[0,1] op_sel_hi:[1,1]
  v_pk_mul_f32 v[156:157], v[156:157], v[164:165] op_sel:[0,1] op_sel_hi:[1,1]
  v_pk_mul_f32 v[158:159], v[158:159], v[164:165] op_sel:[0,1] op_sel_hi:[1,1]
  v_cvt_pk_bf16_f32 v168, v152, v153
  v_cvt_pk_bf16_f32 v169, v154, v155
  v_cvt_pk_bf16_f32 v170, v156, v157
  v_cvt_pk_bf16_f32 v171, v158, v159
  v_lshlrev_b32 v152, 16, v168
  v_and_b32 v153, 0xffff0000, v168
  v_lshlrev_b32 v154, 16, v169
  v_and_b32 v155, 0xffff0000, v169
  v_lshlrev_b32 v156, 16, v170
  v_and_b32 v157, 0xffff0000, v170
  v_lshlrev_b32 v158, 16, v171
  v_and_b32 v159, 0xffff0000, v171
  v_lshlrev_b32 v5, 5, v1
  ds_write_b128 v5, v[144:147] offset:0
  ds_write_b128 v5, v[148:151] offset:16
  ds_write_b128 v5, v[152:155] offset:2048
  ds_write_b128 v5, v[156:159] offset:2064
  s_waitcnt lgkmcnt(0)
  s_add_u32 s26, s26, 1
  v_lshrrev_b32 v5, 2, v0
  v_lshlrev_b32 v5, 2, v5
  ds_read2st64_b32 v[168:169], v5 offset0:0 offset1:8
  ds_read2st64_b32 v[170:171], v5 offset0:1 offset1:9
  ds_read2st64_b32 v[172:173], v5 offset0:2 offset1:10
  ds_read2st64_b32 v[174:175], v5 offset0:3 offset1:11
  ds_read2st64_b32 v[176:177], v5 offset0:4 offset1:12
  ds_read2st64_b32 v[178:179], v5 offset0:5 offset1:13
  ds_read2st64_b32 v[180:181], v5 offset0:6 offset1:14
  ds_read2st64_b32 v[182:183], v5 offset0:7 offset1:15
  v_mov_b32 v7, 7168
  v_mov_b32 v8, 1
  v_lshlrev_b32 v9, 3, v1
  s_waitcnt vmcnt(0) lgkmcnt(0)
  v_lshlrev_b32 v160, 16, v212
  v_and_b32 v161, 0xffff0000, v212
  v_pk_mul_f32 v[184:185], v[160:161], v[168:169] op_sel_hi:[1,0]
  v_pk_mul_f32 v[188:189], v[160:161], v[168:169] op_sel:[0,1] op_sel_hi:[1,1]
  v_lshlrev_b32 v160, 16, v213
  v_and_b32 v161, 0xffff0000, v213
  v_pk_mul_f32 v[186:187], v[160:161], v[168:169] op_sel_hi:[1,0]
  v_pk_mul_f32 v[190:191], v[160:161], v[168:169] op_sel:[0,1] op_sel_hi:[1,1]
  v_lshlrev_b32 v160, 16, v214
  v_and_b32 v161, 0xffff0000, v214
  v_pk_fma_f32 v[184:185], v[160:161], v[170:171], v[184:185] op_sel_hi:[1,0,1]
  v_pk_fma_f32 v[188:189], v[160:161], v[170:171], v[188:189] op_sel:[0,1,0] op_sel_hi:[1,1,1]
  v_lshlrev_b32 v160, 16, v215
  v_and_b32 v161, 0xffff0000, v215
  v_pk_fma_f32 v[186:187], v[160:161], v[170:171], v[186:187] op_sel_hi:[1,0,1]
  v_pk_fma_f32 v[190:191], v[160:161], v[170:171], v[190:191] op_sel:[0,1,0] op_sel_hi:[1,1,1]
  v_lshlrev_b32 v160, 16, v216
  v_and_b32 v161, 0xffff0000, v216
  v_pk_fma_f32 v[184:185], v[160:161], v[172:173], v[184:185] op_sel_hi:[1,0,1]
  v_pk_fma_f32 v[188:189], v[160:161], v[172:173], v[188:189] op_sel:[0,1,0] op_sel_hi:[1,1,1]
  v_lshlrev_b32 v160, 16, v217
  v_and_b32 v161, 0xffff0000, v217
  v_pk_fma_f32 v[186:187], v[160:161], v[172:173], v[186:187] op_sel_hi:[1,0,1]
  v_pk_fma_f32 v[190:191], v[160:161], v[172:173], v[190:191] op_sel:[0,1,0] op_sel_hi:[1,1,1]
  v_lshlrev_b32 v160, 16, v218
  v_and_b32 v161, 0xffff0000, v218
  v_pk_fma_f32 v[184:185], v[160:161], v[174:175], v[184:185] op_sel_hi:[1,0,1]
  v_pk_fma_f32 v[188:189], v[160:161], v[174:175], v[188:189] op_sel:[0,1,0] op_sel_hi:[1,1,1]
  v_lshlrev_b32 v160, 16, v219
  v_and_b32 v161, 0xffff0000, v219
  v_pk_fma_f32 v[186:187], v[160:161], v[174:175], v[186:187] op_sel_hi:[1,0,1]
  v_pk_fma_f32 v[190:191], v[160:161], v[174:175], v[190:191] op_sel:[0,1,0] op_sel_hi:[1,1,1]
  v_lshlrev_b32 v160, 16, v220
  v_and_b32 v161, 0xffff0000, v220
  v_pk_fma_f32 v[184:185], v[160:161], v[176:177], v[184:185] op_sel_hi:[1,0,1]
  v_pk_fma_f32 v[188:189], v[160:161], v[176:177], v[188:189] op_sel:[0,1,0] op_sel_hi:[1,1,1]
  v_lshlrev_b32 v160, 16, v221
  v_and_b32 v161, 0xffff0000, v221
  v_pk_fma_f32 v[186:187], v[160:161], v[176:177], v[186:187] op_sel_hi:[1,0,1]
  v_pk_fma_f32 v[190:191], v[160:161], v[176:177], v[190:191] op_sel:[0,1,0] op_sel_hi:[1,1,1]
  v_lshlrev_b32 v160, 16, v222
  v_and_b32 v161, 0xffff0000, v222
  v_pk_fma_f32 v[184:185], v[160:161], v[178:179], v[184:185] op_sel_hi:[1,0,1]
  v_pk_fma_f32 v[188:189], v[160:161], v[178:179], v[188:189] op_sel:[0,1,0] op_sel_hi:[1,1,1]
  v_lshlrev_b32 v160, 16, v223
  v_and_b32 v161, 0xffff0000, v223
  v_pk_fma_f32 v[186:187], v[160:161], v[178:179], v[186:187] op_sel_hi:[1,0,1]
  v_pk_fma_f32 v[190:191], v[160:161], v[178:179], v[190:191] op_sel:[0,1,0] op_sel_hi:[1,1,1]
  v_lshlrev_b32 v160, 16, v224
  v_and_b32 v161, 0xffff0000, v224
  v_pk_fma_f32 v[184:185], v[160:161], v[180:181], v[184:185] op_sel_hi:[1,0,1]
  v_pk_fma_f32 v[188:189], v[160:161], v[180:181], v[188:189] op_sel:[0,1,0] op_sel_hi:[1,1,1]
  v_lshlrev_b32 v160, 16, v225
  v_and_b32 v161, 0xffff0000, v225
  v_pk_fma_f32 v[186:187], v[160:161], v[180:181], v[186:187] op_sel_hi:[1,0,1]
  v_pk_fma_f32 v[190:191], v[160:161], v[180:181], v[190:191] op_sel:[0,1,0] op_sel_hi:[1,1,1]
  v_lshlrev_b32 v160, 16, v226
  v_and_b32 v161, 0xffff0000, v226
  v_pk_fma_f32 v[184:185], v[160:161], v[182:183], v[184:185] op_sel_hi:[1,0,1]
  v_pk_fma_f32 v[188:189], v[160:161], v[182:183], v[188:189] op_sel:[0,1,0] op_sel_hi:[1,1,1]
  v_lshlrev_b32 v160, 16, v227
  v_and_b32 v161, 0xffff0000, v227
  v_pk_fma_f32 v[186:187], v[160:161], v[182:183], v[186:187] op_sel_hi:[1,0,1]
  v_pk_fma_f32 v[190:191], v[160:161], v[182:183], v[190:191] op_sel:[0,1,0] op_sel_hi:[1,1,1]
  s_nop 1
  v_add_f32_dpp v184, v184, v184 row_ror:4 row_mask:0xf bank_mask:0xf
  v_add_f32_dpp v185, v185, v185 row_ror:4 row_mask:0xf bank_mask:0xf
  v_add_f32_dpp v186, v186, v186 row_ror:4 row_mask:0xf bank_mask:0xf
  v_add_f32_dpp v187, v187, v187 row_ror:4 row_mask:0xf bank_mask:0xf
  v_add_f32_dpp v188, v188, v188 row_ror:4 row_mask:0xf bank_mask:0xf
  v_add_f32_dpp v189, v189, v189 row_ror:4 row_mask:0xf bank_mask:0xf
  v_add_f32_dpp v190, v190, v190 row_ror:4 row_mask:0xf bank_mask:0xf
  v_add_f32_dpp v191, v191, v191 row_ror:4 row_mask:0xf bank_mask:0xf
  s_nop 1
  v_add_f32_dpp v184, v184, v184 row_ror:8 row_mask:0xf bank_mask:0xf
  v_add_f32_dpp v185, v185, v185 row_ror:8 row_mask:0xf bank_mask:0xf
  v_add_f32_dpp v186, v186, v186 row_ror:8 row_mask:0xf bank_mask:0xf
  v_add_f32_dpp v187, v187, v187 row_ror:8 row_mask:0xf bank_mask:0xf
  v_add_f32_dpp v188, v188, v188 row_ror:8 row_mask:0xf bank_mask:0xf
  v_add_f32_dpp v189, v189, v189 row_ror:8 row_mask:0xf bank_mask:0xf
  v_add_f32_dpp v190, v190, v190 row_ror:8 row_mask:0xf bank_mask:0xf
  v_add_f32_dpp v191, v191, v191 row_ror:8 row_mask:0xf bank_mask:0xf
  v_mov_b32 v204, v184
  v_mov_b32 v205, v185
  v_mov_b32 v206, v186
  v_mov_b32 v207, v187
  v_mov_b32 v208, v188
  v_mov_b32 v209, v189
  v_mov_b32 v210, v190
  v_mov_b32 v211, v191
  s_nop 1
  v_permlane16_swap_b32 v184, v204
  v_permlane16_swap_b32 v185, v205
  v_permlane16_swap_b32 v186, v206
  v_permlane16_swap_b32 v187, v207
  v_permlane16_swap_b32 v188, v208
  v_permlane16_swap_b32 v189, v209
  v_permlane16_swap_b32 v190, v210
  v_permlane16_swap_b32 v191, v211
  s_nop 1
  v_add_f32 v184, v184, v204
  v_add_f32 v185, v185, v205
  v_add_f32 v186, v186, v206
  v_add_f32 v187, v187, v207
  v_add_f32 v188, v188, v208
  v_add_f32 v189, v189, v209
  v_add_f32 v190, v190, v210
  v_add_f32 v191, v191, v211
  v_mov_b32 v204, v184
  v_mov_b32 v205, v185
  v_mov_b32 v206, v186
  v_mov_b32 v207, v187
  v_mov_b32 v208, v188
  v_mov_b32 v209, v189
  v_mov_b32 v210, v190
  v_mov_b32 v211, v191
  s_nop 1
  v_permlane32_swap_b32 v184, v204
  v_permlane32_swap_b32 v185, v205
  v_permlane32_swap_b32 v186, v206
  v_permlane32_swap_b32 v187, v207
  v_permlane32_swap_b32 v188, v208
  v_permlane32_swap_b32 v189, v209
  v_permlane32_swap_b32 v190, v210
  v_permlane32_swap_b32 v191, v211
  s_nop 1
  v_add_f32 v184, v184, v204
  v_add_f32 v185, v185, v205
  v_add_f32 v186, v186, v206
  v_add_f32 v187, v187, v207
  v_add_f32 v188, v188, v208
  v_add_f32 v189, v189, v209
  v_add_f32 v190, v190, v210
  v_add_f32 v191, v191, v211
  s_mov_b64 exec, 0xf
  ds_write_b128 v231, v[184:187] offset:4096
  ds_write_b128 v231, v[188:191] offset:4160
  s_mov_b64 exec, 1
  ds_add_rtn_u32 v6, v7, v8 offset:16
  s_mov_b64 exec, -1
  s_waitcnt lgkmcnt(0)
  v_readfirstlane_b32 s75, v6
  s_cmp_lg_u32 s75, 3
  s_cbranch_scc1 K_QW
  s_mov_b64 exec, 0xffff
  ds_read_b64 v[160:161], v9 offset:4096
  ds_read_b64 v[162:163], v9 offset:4288
  ds_read_b64 v[164:165], v9 offset:4480
  ds_read_b64 v[166:167], v9 offset:4672
  v_mov_b32 v169, s26
  s_waitcnt lgkmcnt(0)
  v_pk_add_f32 v[160:161], v[160:161], v[162:163]
  v_pk_add_f32 v[164:165], v[164:165], v[166:167]
  v_pk_add_f32 v[160:161], v[160:161], v[164:165]
  v_cvt_pk_bf16_f32 v168, v160, v161
  buffer_store_dwordx2 v[168:169], v230, s[20:23], 0 offen sc1
  s_mov_b64 exec, 1
  ds_add_u32 v7, v8 offset:20
  ds_add_u32 v7, v8 offset:24
  s_mov_b64 exec, -1
K_QW:
  s_mov_b32 s74, 0x100000
K_QWL:
  ds_read_b32 v6, v7 offset:20
  s_waitcnt lgkmcnt(0)
  v_readfirstlane_b32 s75, v6
  s_cmp_ge_u32 s75, 5
  s_cbranch_scc1 K_QGO
  s_sub_u32 s74, s74, 1
  s_cmp_lg_u32 s74, 0
  s_cbranch_scc1 K_QWL
K_QGO:
  s_lshl_b32 s72, s88, 14
  s_lshl_b32 s76, s86, 11
  s_add_u32 s72, s72, s76
  s_lshl_b32 s76, s3, 8
  s_add_u32 s72, s72, s76
  s_add_u32 s72, s72, 2097152
  s_lshl_b32 s76, s3, 7
  v_lshlrev_b32 v6, 2, v1
  v_add_u32 v6, s76, v6
  s_load_dwordx16 s[4:19], s[24:25], s72 offset:0 glc
  s_load_dwordx16 s[28:43], s[24:25], s72 offset:64 glc
  s_load_dwordx16 s[44:59], s[24:25], s72 offset:128 glc
  s_load_dwordx16 s[80:95], s[24:25], s72 offset:192 glc
  buffer_load_dwordx4 v[16:19], v228, s[60:63], 0 offen offset:0 nt
  buffer_load_dwordx4 v[20:23], v228, s[60:63], 0 offen offset:64 nt
  buffer_load_dwordx4 v[24:27], v228, s[60:63], 0 offen offset:128 nt
  buffer_load_dwordx4 v[28:31], v228, s[60:63], 0 offen offset:192 nt
  s_waitcnt lgkmcnt(0)
  s_and_b64 s[76:77], s[4:5], s[6:7]
  s_or_b64 s[78:79], s[4:5], s[6:7]
  s_and_b64 s[76:77], s[76:77], s[8:9]
  s_or_b64 s[78:79], s[78:79], s[8:9]
  s_and_b64 s[76:77], s[76:77], s[10:11]
  s_or_b64 s[78:79], s[78:79], s[10:11]
  s_and_b64 s[76:77], s[76:77], s[12:13]
  s_or_b64 s[78:79], s[78:79], s[12:13]
  s_and_b64 s[76:77], s[76:77], s[14:15]
  s_or_b64 s[78:79], s[78:79], s[14:15]
  s_and_b64 s[76:77], s[76:77], s[16:17]
  s_or_b64 s[78:79], s[78:79], s[16:17]
  s_and_b64 s[76:77], s[76:77], s[18:19]
  s_or_b64 s[78:79], s[78:79], s[18:19]
  s_and_b64 s[76:77], s[76:77], s[28:29]
  s_or_b64 s[78:79], s[78:79], s[28:29]
  s_and_b64 s[76:77], s[76:77], s[30:31]
  s_or_b64 s[78:79], s[78:79], s[30:31]
  s_and_b64 s[76:77], s[76:77], s[32:33]
  s_or_b64 s[78:79], s[78:79], s[32:33]
  s_and_b64 s[76:77], s[76:77], s[34:35]
  s_or_b64 s[78:79], s[78:79], s[34:35]
  s_and_b64 s[76:77], s[76:77], s[36:37]
  s_or_b64 s[78:79], s[78:79], s[36:37]
  s_and_b64 s[76:77], s[76:77], s[38:39]
  s_or_b64 s[78:79], s[78:79], s[38:39]
  s_and_b64 s[76:77], s[76:77], s[40:41]
  s_or_b64 s[78:79], s[78:79], s[40:41]
  s_and_b64 s[76:77], s[76:77], s[42:43]
  s_or_b64 s[78:79], s[78:79], s[42:43]
  s_and_b64 s[76:77], s[76:77], s[44:45]
  s_or_b64 s[78:79], s[78:79], s[44:45]
  s_and_b64 s[76:77], s[76:77], s[46:47]
  s_or_b64 s[78:79], s[78:79], s[46:47]
  s_and_b64 s[76:77], s[76:77], s[48:49]
  s_or_b64 s[78:79], s[78:79], s[48:49]
  s_and_b64 s[76:77], s[76:77], s[50:51]
  s_or_b64 s[78:79], s[78:79], s[50:51]
  s_and_b64 s[76:77], s[76:77], s[52:53]
  s_or_b64 s[78:79], s[78:79], s[52:53]
  s_and_b64 s[76:77], s[76:77], s[54:55]
  s_or_b64 s[78:79], s[78:79], s[54:55]
  s_and_b64 s[76:77], s[76:77], s[56:57]
  s_or_b64 s[78:79], s[78:79], s[56:57]
  s_and_b64 s[76:77], s[76:77], s[58:59]
  s_or_b64 s[78:79], s[78:79], s[58:59]
  s_and_b64 s[76:77], s[76:77], s[80:81]
  s_or_b64 s[78:79], s[78:79], s[80:81]
  s_and_b64 s[76:77], s[76:77], s[82:83]
  s_or_b64 s[78:79], s[78:79], s[82:83]
  s_and_b64 s[76:77], s[76:77], s[84:85]
  s_or_b64 s[78:79], s[78:79], s[84:85]
  s_and_b64 s[76:77], s[76:77], s[86:87]
  s_or_b64 s[78:79], s[78:79], s[86:87]
  s_and_b64 s[76:77], s[76:77], s[88:89]
  s_or_b64 s[78:79], s[78:79], s[88:89]
  s_and_b64 s[76:77], s[76:77], s[90:91]
  s_or_b64 s[78:79], s[78:79], s[90:91]
  s_and_b64 s[76:77], s[76:77], s[92:93]
  s_or_b64 s[78:79], s[78:79], s[92:93]
  s_and_b64 s[76:77], s[76:77], s[94:95]
  s_or_b64 s[78:79], s[78:79], s[94:95]
  s_xor_b32 s77, s77, s26
  s_xor_b32 s79, s79, s26
  s_or_b32 s77, s77, s79
  s_cmp_eq_u32 s77, 0
  s_cbranch_scc1 K_QP0
  s_load_dwordx16 s[4:19], s[24:25], s72 offset:0 glc
  s_load_dwordx16 s[28:43], s[24:25], s72 offset:64 glc
  s_load_dwordx16 s[44:59], s[24:25], s72 offset:128 glc
  s_load_dwordx16 s[80:95], s[24:25], s72 offset:192 glc
  buffer_load_dwordx4 v[32:35], v228, s[60:63], s71 offen offset:0 nt
  buffer_load_dwordx4 v[36:39], v228, s[60:63], s71 offen offset:64 nt
  buffer_load_dwordx4 v[40:43], v228, s[60:63], s71 offen offset:128 nt
  buffer_load_dwordx4 v[44:47], v228, s[60:63], s71 offen offset:192 nt
  s_waitcnt lgkmcnt(0)
  s_and_b64 s[76:77], s[4:5], s[6:7]
  s_or_b64 s[78:79], s[4:5], s[6:7]
  s_and_b64 s[76:77], s[76:77], s[8:9]
  s_or_b64 s[78:79], s[78:79], s[8:9]
  s_and_b64 s[76:77], s[76:77], s[10:11]
  s_or_b64 s[78:79], s[78:79], s[10:11]
  s_and_b64 s[76:77], s[76:77], s[12:13]
  s_or_b64 s[78:79], s[78:79], s[12:13]
  s_and_b64 s[76:77], s[76:77], s[14:15]
  s_or_b64 s[78:79], s[78:79], s[14:15]
  s_and_b64 s[76:77], s[76:77], s[16:17]
  s_or_b64 s[78:79], s[78:79], s[16:17]
  s_and_b64 s[76:77], s[76:77], s[18:19]
  s_or_b64 s[78:79], s[78:79], s[18:19]
  s_and_b64 s[76:77], s[76:77], s[28:29]
  s_or_b64 s[78:79], s[78:79], s[28:29]
  s_and_b64 s[76:77], s[76:77], s[30:31]
  s_or_b64 s[78:79], s[78:79], s[30:31]
  s_and_b64 s[76:77], s[76:77], s[32:33]
  s_or_b64 s[78:79], s[78:79], s[32:33]
  s_and_b64 s[76:77], s[76:77], s[34:35]
  s_or_b64 s[78:79], s[78:79], s[34:35]
  s_and_b64 s[76:77], s[76:77], s[36:37]
  s_or_b64 s[78:79], s[78:79], s[36:37]
  s_and_b64 s[76:77], s[76:77], s[38:39]
  s_or_b64 s[78:79], s[78:79], s[38:39]
  s_and_b64 s[76:77], s[76:77], s[40:41]
  s_or_b64 s[78:79], s[78:79], s[40:41]
  s_and_b64 s[76:77], s[76:77], s[42:43]
  s_or_b64 s[78:79], s[78:79], s[42:43]
  s_and_b64 s[76:77], s[76:77], s[44:45]
  s_or_b64 s[78:79], s[78:79], s[44:45]
  s_and_b64 s[76:77], s[76:77], s[46:47]
  s_or_b64 s[78:79], s[78:79], s[46:47]
  s_and_b64 s[76:77], s[76:77], s[48:49]
  s_or_b64 s[78:79], s[78:79], s[48:49]
  s_and_b64 s[76:77], s[76:77], s[50:51]
  s_or_b64 s[78:79], s[78:79], s[50:51]
  s_and_b64 s[76:77], s[76:77], s[52:53]
  s_or_b64 s[78:79], s[78:79], s[52:53]
  s_and_b64 s[76:77], s[76:77], s[54:55]
  s_or_b64 s[78:79], s[78:79], s[54:55]
  s_and_b64 s[76:77], s[76:77], s[56:57]
  s_or_b64 s[78:79], s[78:79], s[56:57]
  s_and_b64 s[76:77], s[76:77], s[58:59]
  s_or_b64 s[78:79], s[78:79], s[58:59]
  s_and_b64 s[76:77], s[76:77], s[80:81]
  s_or_b64 s[78:79], s[78:79], s[80:81]
  s_and_b64 s[76:77], s[76:77], s[82:83]
  s_or_b64 s[78:79], s[78:79], s[82:83]
  s_and_b64 s[76:77], s[76:77], s[84:85]
  s_or_b64 s[78:79], s[78:79], s[84:85]
  s_and_b64 s[76:77], s[76:77], s[86:87]
  s_or_b64 s[78:79], s[78:79], s[86:87]
  s_and_b64 s[76:77], s[76:77], s[88:89]
  s_or_b64 s[78:79], s[78:79], s[88:89]
  s_and_b64 s[76:77], s[76:77], s[90:91]
  s_or_b64 s[78:79], s[78:79], s[90:91]
  s_and_b64 s[76:77], s[76:77], s[92:93]
  s_or_b64 s[78:79], s[78:79], s[92:93]
  s_and_b64 s[76:77], s[76:77], s[94:95]
  s_or_b64 s[78:79], s[78:79], s[94:95]
  s_xor_b32 s77, s77, s26
  s_xor_b32 s79, s79, s26
  s_or_b32 s77, s77, s79
  s_cmp_eq_u32 s77, 0
  s_cbranch_scc1 K_QP1
  s_load_dwordx16 s[4:19], s[24:25], s72 offset:0 glc
  s_load_dwordx16 s[28:43], s[24:25], s72 offset:64 glc
  s_load_dwordx16 s[44:59], s[24:25], s72 offset:128 glc
  s_load_dwordx16 s[80:95], s[24:25], s72 offset:192 glc
  buffer_load_dwordx4 v[48:51], v229, s[64:67], 0 offen offset:0 nt
  buffer_load_dwordx4 v[52:55], v229, s[64:67], 0 offen offset:1024 nt
  buffer_load_dwordx4 v[56:59], v229, s[64:67], 0 offen offset:2048 nt
  buffer_load_dwordx4 v[60:63], v229, s[64:67], 0 offen offset:3072 nt
  s_waitcnt lgkmcnt(0)
  s_and_b64 s[76:77], s[4:5], s[6:7]
  s_or_b64 s[78:79], s[4:5], s[6:7]
  s_and_b64 s[76:77], s[76:77], s[8:9]
  s_or_b64 s[78:79], s[78:79], s[8:9]
  s_and_b64 s[76:77], s[76:77], s[10:11]
  s_or_b64 s[78:79], s[78:79], s[10:11]
  s_and_b64 s[76:77], s[76:77], s[12:13]
  s_or_b64 s[78:79], s[78:79], s[12:13]
  s_and_b64 s[76:77], s[76:77], s[14:15]
  s_or_b64 s[78:79], s[78:79], s[14:15]
  s_and_b64 s[76:77], s[76:77], s[16:17]
  s_or_b64 s[78:79], s[78:79], s[16:17]
  s_and_b64 s[76:77], s[76:77], s[18:19]
  s_or_b64 s[78:79], s[78:79], s[18:19]
  s_and_b64 s[76:77], s[76:77], s[28:29]
  s_or_b64 s[78:79], s[78:79], s[28:29]
  s_and_b64 s[76:77], s[76:77], s[30:31]
  s_or_b64 s[78:79], s[78:79], s[30:31]
  s_and_b64 s[76:77], s[76:77], s[32:33]
  s_or_b64 s[78:79], s[78:79], s[32:33]
  s_and_b64 s[76:77], s[76:77], s[34:35]
  s_or_b64 s[78:79], s[78:79], s[34:35]
  s_and_b64 s[76:77], s[76:77], s[36:37]
  s_or_b64 s[78:79], s[78:79], s[36:37]
  s_and_b64 s[76:77], s[76:77], s[38:39]
  s_or_b64 s[78:79], s[78:79], s[38:39]
  s_and_b64 s[76:77], s[76:77], s[40:41]
  s_or_b64 s[78:79], s[78:79], s[40:41]
  s_and_b64 s[76:77], s[76:77], s[42:43]
  s_or_b64 s[78:79], s[78:79], s[42:43]
  s_and_b64 s[76:77], s[76:77], s[44:45]
  s_or_b64 s[78:79], s[78:79], s[44:45]
  s_and_b64 s[76:77], s[76:77], s[46:47]
  s_or_b64 s[78:79], s[78:79], s[46:47]
  s_and_b64 s[76:77], s[76:77], s[48:49]
  s_or_b64 s[78:79], s[78:79], s[48:49]
  s_and_b64 s[76:77], s[76:77], s[50:51]
  s_or_b64 s[78:79], s[78:79], s[50:51]
  s_and_b64 s[76:77], s[76:77], s[52:53]
  s_or_b64 s[78:79], s[78:79], s[52:53]
  s_and_b64 s[76:77], s[76:77], s[54:55]
  s_or_b64 s[78:79], s[78:79], s[54:55]
  s_and_b64 s[76:77], s[76:77], s[56:57]
  s_or_b64 s[78:79], s[78:79], s[56:57]
  s_and_b64 s[76:77], s[76:77], s[58:59]
  s_or_b64 s[78:79], s[78:79], s[58:59]
  s_and_b64 s[76:77], s[76:77], s[80:81]
  s_or_b64 s[78:79], s[78:79], s[80:81]
  s_and_b64 s[76:77], s[76:77], s[82:83]
  s_or_b64 s[78:79], s[78:79], s[82:83]
  s_and_b64 s[76:77], s[76:77], s[84:85]
  s_or_b64 s[78:79], s[78:79], s[84:85]
  s_and_b64 s[76:77], s[76:77], s[86:87]
  s_or_b64 s[78:79], s[78:79], s[86:87]
  s_and_b64 s[76:77], s[76:77], s[88:89]
  s_or_b64 s[78:79], s[78:79], s[88:89]
  s_and_b64 s[76:77], s[76:77], s[90:91]
  s_or_b64 s[78:79], s[78:79], s[90:91]
  s_and_b64 s[76:77], s[76:77], s[92:93]
  s_or_b64 s[78:79], s[78:79], s[92:93]
  s_and_b64 s[76:77], s[76:77], s[94:95]
  s_or_b64 s[78:79], s[78:79], s[94:95]
  s_xor_b32 s77, s77, s26
  s_xor_b32 s79, s79, s26
  s_or_b32 s77, s77, s79
  s_cmp_eq_u32 s77, 0
  s_cbranch_scc1 K_QP2
  s_load_dwordx16 s[4:19], s[24:25], s72 offset:0 glc
  s_load_dwordx16 s[28:43], s[24:25], s72 offset:64 glc
  s_load_dwordx16 s[44:59], s[24:25], s72 offset:128 glc
  s_load_dwordx16 s[80:95], s[24:25], s72 offset:192 glc
  buffer_load_dwordx4 v[64:67], v229, s[64:67], s71 offen offset:0 nt
  buffer_load_dwordx4 v[68:71], v229, s[64:67], s71 offen offset:1024 nt
  buffer_load_dwordx4 v[72:75], v229, s[64:67], s71 offen offset:2048 nt
  buffer_load_dwordx4 v[76:79], v229, s[64:67], s71 offen offset:3072 nt
  s_waitcnt lgkmcnt(0)
  s_and_b64 s[76:77], s[4:5], s[6:7]
  s_or_b64 s[78:79], s[4:5], s[6:7]
  s_and_b64 s[76:77], s[76:77], s[8:9]
  s_or_b64 s[78:79], s[78:79], s[8:9]
  s_and_b64 s[76:77], s[76:77], s[10:11]
  s_or_b64 s[78:79], s[78:79], s[10:11]
  s_and_b64 s[76:77], s[76:77], s[12:13]
  s_or_b64 s[78:79], s[78:79], s[12:13]
  s_and_b64 s[76:77], s[76:77], s[14:15]
  s_or_b64 s[78:79], s[78:79], s[14:15]
  s_and_b64 s[76:77], s[76:77], s[16:17]
  s_or_b64 s[78:79], s[78:79], s[16:17]
  s_and_b64 s[76:77], s[76:77], s[18:19]
  s_or_b64 s[78:79], s[78:79], s[18:19]
  s_and_b64 s[76:77], s[76:77], s[28:29]
  s_or_b64 s[78:79], s[78:79], s[28:29]
  s_and_b64 s[76:77], s[76:77], s[30:31]
  s_or_b64 s[78:79], s[78:79], s[30:31]
  s_and_b64 s[76:77], s[76:77], s[32:33]
  s_or_b64 s[78:79], s[78:79], s[32:33]
  s_and_b64 s[76:77], s[76:77], s[34:35]
  s_or_b64 s[78:79], s[78:79], s[34:35]
  s_and_b64 s[76:77], s[76:77], s[36:37]
  s_or_b64 s[78:79], s[78:79], s[36:37]
  s_and_b64 s[76:77], s[76:77], s[38:39]
  s_or_b64 s[78:79], s[78:79], s[38:39]
  s_and_b64 s[76:77], s[76:77], s[40:41]
  s_or_b64 s[78:79], s[78:79], s[40:41]
  s_and_b64 s[76:77], s[76:77], s[42:43]
  s_or_b64 s[78:79], s[78:79], s[42:43]
  s_and_b64 s[76:77], s[76:77], s[44:45]
  s_or_b64 s[78:79], s[78:79], s[44:45]
  s_and_b64 s[76:77], s[76:77], s[46:47]
  s_or_b64 s[78:79], s[78:79], s[46:47]
  s_and_b64 s[76:77], s[76:77], s[48:49]
  s_or_b64 s[78:79], s[78:79], s[48:49]
  s_and_b64 s[76:77], s[76:77], s[50:51]
  s_or_b64 s[78:79], s[78:79], s[50:51]
  s_and_b64 s[76:77], s[76:77], s[52:53]
  s_or_b64 s[78:79], s[78:79], s[52:53]
  s_and_b64 s[76:77], s[76:77], s[54:55]
  s_or_b64 s[78:79], s[78:79], s[54:55]
  s_and_b64 s[76:77], s[76:77], s[56:57]
  s_or_b64 s[78:79], s[78:79], s[56:57]
  s_and_b64 s[76:77], s[76:77], s[58:59]
  s_or_b64 s[78:79], s[78:79], s[58:59]
  s_and_b64 s[76:77], s[76:77], s[80:81]
  s_or_b64 s[78:79], s[78:79], s[80:81]
  s_and_b64 s[76:77], s[76:77], s[82:83]
  s_or_b64 s[78:79], s[78:79], s[82:83]
  s_and_b64 s[76:77], s[76:77], s[84:85]
  s_or_b64 s[78:79], s[78:79], s[84:85]
  s_and_b64 s[76:77], s[76:77], s[86:87]
  s_or_b64 s[78:79], s[78:79], s[86:87]
  s_and_b64 s[76:77], s[76:77], s[88:89]
  s_or_b64 s[78:79], s[78:79], s[88:89]
  s_and_b64 s[76:77], s[76:77], s[90:91]
  s_or_b64 s[78:79], s[78:79], s[90:91]
  s_and_b64 s[76:77], s[76:77], s[92:93]
  s_or_b64 s[78:79], s[78:79], s[92:93]
  s_and_b64 s[76:77], s[76:77], s[94:95]
  s_or_b64 s[78:79], s[78:79], s[94:95]
  s_xor_b32 s77, s77, s26
  s_xor_b32 s79, s79, s26
  s_or_b32 s77, s77, s79
  s_cmp_eq_u32 s77, 0
  s_cbranch_scc1 K_QP3
  s_branch K_SPL
K_QP0:
  v_writelane_b32 v5, s4, 0
  v_writelane_b32 v5, s6, 1
  v_writelane_b32 v5, s8, 2
  v_writelane_b32 v5, s10, 3
  v_writelane_b32 v5, s12, 4
  v_writelane_b32 v5, s14, 5
  v_writelane_b32 v5, s16, 6
  v_writelane_b32 v5, s18, 7
  v_writelane_b32 v5, s28, 8
  v_writelane_b32 v5, s30, 9
  v_writelane_b32 v5, s32, 10
  v_writelane_b32 v5, s34, 11
  v_writelane_b32 v5, s36, 12
  v_writelane_b32 v5, s38, 13
  v_writelane_b32 v5, s40, 14
  v_writelane_b32 v5, s42, 15
  v_writelane_b32 v5, s44, 16
  v_writelane_b32 v5, s46, 17
  v_writelane_b32 v5, s48, 18
  v_writelane_b32 v5, s50, 19
  v_writelane_b32 v5, s52, 20
  v_writelane_b32 v5, s54, 21
  v_writelane_b32 v5, s56, 22
  v_writelane_b32 v5, s58, 23
  v_writelane_b32 v5, s80, 24
  v_writelane_b32 v5, s82, 25
  v_writelane_b32 v5, s84, 26
  v_writelane_b32 v5, s86, 27
  v_writelane_b32 v5, s88, 28
  v_writelane_b32 v5, s90, 29
  v_writelane_b32 v5, s92, 30
  v_writelane_b32 v5, s94, 31
  s_mov_b64 exec, 0xffffffff
  ds_write_b32 v6, v5 offset:5632
  s_mov_b64 exec, 1
  ds_add_u32 v7, v8 offset:24
  s_mov_b64 exec, -1
  buffer_load_dwordx4 v[32:35], v228, s[60:63], s71 offen offset:0 nt
  buffer_load_dwordx4 v[36:39], v228, s[60:63], s71 offen offset:64 nt
  buffer_load_dwordx4 v[40:43], v228, s[60:63], s71 offen offset:128 nt
  buffer_load_dwordx4 v[44:47], v228, s[60:63], s71 offen offset:192 nt
  buffer_load_dwordx4 v[48:51], v229, s[64:67], 0 offen offset:0 nt
  buffer_load_dwordx4 v[52:55], v229, s[64:67], 0 offen offset:1024 nt
  buffer_load_dwordx4 v[56:59], v229, s[64:67], 0 offen offset:2048 nt
  buffer_load_dwordx4 v[60:63], v229, s[64:67], 0 offen offset:3072 nt
  buffer_load_dwordx4 v[64:67], v229, s[64:67], s71 offen offset:0 nt
  buffer_load_dwordx4 v[68:71], v229, s[64:67], s71 offen offset:1024 nt
  buffer_load_dwordx4 v[72:75], v229, s[64:67], s71 offen offset:2048 nt
  buffer_load_dwordx4 v[76:79], v229, s[64:67], s71 offen offset:3072 nt
  s_branch K_QR
K_QP1:
  v_writelane_b32 v5, s4, 0
  v_writelane_b32 v5, s6, 1
  v_writelane_b32 v5, s8, 2
  v_writelane_b32 v5, s10, 3
  v_writelane_b32 v5, s12, 4
  v_writelane_b32 v5, s14, 5
  v_writelane_b32 v5, s16, 6
  v_writelane_b32 v5, s18, 7
  v_writelane_b32 v5, s28, 8
  v_writelane_b32 v5, s30, 9
  v_writelane_b32 v5, s32, 10
  v_writelane_b32 v5, s34, 11
  v_writelane_b32 v5, s36, 12
  v_writelane_b32 v5, s38, 13
  v_writelane_b32 v5, s40, 14
  v_writelane_b32 v5, s42, 15
  v_writelane_b32 v5, s44, 16
  v_writelane_b32 v5, s46, 17
  v_writelane_b32 v5, s48, 18
  v_writelane_b32 v5, s50, 19
  v_writelane_b32 v5, s52, 20
  v_writelane_b32 v5, s54, 21
  v_writelane_b32 v5, s56, 22
  v_writelane_b32 v5, s58, 23
  v_writelane_b32 v5, s80, 24
  v_writelane_b32 v5, s82, 25
  v_writelane_b32 v5, s84, 26
  v_writelane_b32 v5, s86, 27
  v_writelane_b32 v5, s88, 28
  v_writelane_b32 v5, s90, 29
  v_writelane_b32 v5, s92, 30
  v_writelane_b32 v5, s94, 31
  s_mov_b64 exec, 0xffffffff
  ds_write_b32 v6, v5 offset:5632
  s_mov_b64 exec, 1
  ds_add_u32 v7, v8 offset:24
  s_mov_b64 exec, -1
  buffer_load_dwordx4 v[48:51], v229, s[64:67], 0 offen offset:0 nt
  buffer_load_dwordx4 v[52:55], v229, s[64:67], 0 offen offset:1024 nt
  buffer_load_dwordx4 v[56:59], v229, s[64:67], 0 offen offset:2048 nt
  buffer_load_dwordx4 v[60:63], v229, s[64:67], 0 offen offset:3072 nt
  buffer_load_dwordx4 v[64:67], v229, s[64:67], s71 offen offset:0 nt
  buffer_load_dwordx4 v[68:71], v229, s[64:67], s71 offen offset:1024 nt
  buffer_load_dwordx4 v[72:75], v229, s[64:67], s71 offen offset:2048 nt
  buffer_load_dwordx4 v[76:79], v229, s[64:67], s71 offen offset:3072 nt
  s_branch K_QR
K_QP2:
  v_writelane_b32 v5, s4, 0
  v_writelane_b32 v5, s6, 1
  v_writelane_b32 v5, s8, 2
  v_writelane_b32 v5, s10, 3
  v_writelane_b32 v5, s12, 4
  v_writelane_b32 v5, s14, 5
  v_writelane_b32 v5, s16, 6
  v_writelane_b32 v5, s18, 7
  v_writelane_b32 v5, s28, 8
  v_writelane_b32 v5, s30, 9
  v_writelane_b32 v5, s32, 10
  v_writelane_b32 v5, s34, 11
  v_writelane_b32 v5, s36, 12
  v_writelane_b32 v5, s38, 13
  v_writelane_b32 v5, s40, 14
  v_writelane_b32 v5, s42, 15
  v_writelane_b32 v5, s44, 16
  v_writelane_b32 v5, s46, 17
  v_writelane_b32 v5, s48, 18
  v_writelane_b32 v5, s50, 19
  v_writelane_b32 v5, s52, 20
  v_writelane_b32 v5, s54, 21
  v_writelane_b32 v5, s56, 22
  v_writelane_b32 v5, s58, 23
  v_writelane_b32 v5, s80, 24
  v_writelane_b32 v5, s82, 25
  v_writelane_b32 v5, s84, 26
  v_writelane_b32 v5, s86, 27
  v_writelane_b32 v5, s88, 28
  v_writelane_b32 v5, s90, 29
  v_writelane_b32 v5, s92, 30
  v_writelane_b32 v5, s94, 31
  s_mov_b64 exec, 0xffffffff
  ds_write_b32 v6, v5 offset:5632
  s_mov_b64 exec, 1
  ds_add_u32 v7, v8 offset:24
  s_mov_b64 exec, -1
  buffer_load_dwordx4 v[64:67], v229, s[64:67], s71 offen offset:0 nt
  buffer_load_dwordx4 v[68:71], v229, s[64:67], s71 offen offset:1024 nt
  buffer_load_dwordx4 v[72:75], v229, s[64:67], s71 offen offset:2048 nt
  buffer_load_dwordx4 v[76:79], v229, s[64:67], s71 offen offset:3072 nt
  s_branch K_QR
K_QP3:
  v_writelane_b32 v5, s4, 0
  v_writelane_b32 v5, s6, 1
  v_writelane_b32 v5, s8, 2
  v_writelane_b32 v5, s10, 3
  v_writelane_b32 v5, s12, 4
  v_writelane_b32 v5, s14, 5
  v_writelane_b32 v5, s16, 6
  v_writelane_b32 v5, s18, 7
  v_writelane_b32 v5, s28, 8
  v_writelane_b32 v5, s30, 9
  v_writelane_b32 v5, s32, 10
  v_writelane_b32 v5, s34, 11
  v_writelane_b32 v5, s36, 12
  v_writelane_b32 v5, s38, 13
  v_writelane_b32 v5, s40, 14
  v_writelane_b32 v5, s42, 15
  v_writelane_b32 v5, s44, 16
  v_writelane_b32 v5, s46, 17
  v_writelane_b32 v5, s48, 18
  v_writelane_b32 v5, s50, 19
  v_writelane_b32 v5, s52, 20
  v_writelane_b32 v5, s54, 21
  v_writelane_b32 v5, s56, 22
  v_writelane_b32 v5, s58, 23
  v_writelane_b32 v5, s80, 24
  v_writelane_b32 v5, s82, 25
  v_writelane_b32 v5, s84, 26
  v_writelane_b32 v5, s86, 27
  v_writelane_b32 v5, s88, 28
  v_writelane_b32 v5, s90, 29
  v_writelane_b32 v5, s92, 30
  v_writelane_b32 v5, s94, 31
  s_mov_b64 exec, 0xffffffff
  ds_write_b32 v6, v5 offset:5632
  s_mov_b64 exec, 1
  ds_add_u32 v7, v8 offset:24
  s_mov_b64 exec, -1
  s_branch K_QR
K_FLOOD:
  s_barrier
  s_mov_b32 s75, 2162688
  s_load_dword s26, s[24:25], s75
  buffer_load_dwordx4 v[16:19], v228, s[60:63], 0 offen offset:0 nt
  buffer_load_dwordx4 v[20:23], v228, s[60:63], 0 offen offset:64 nt
  buffer_load_dwordx4 v[24:27], v228, s[60:63], 0 offen offset:128 nt
  buffer_load_dwordx4 v[28:31], v228, s[60:63], 0 offen offset:192 nt
  buffer_load_dwordx4 v[32:35], v228, s[60:63], s71 offen offset:0 nt
  buffer_load_dwordx4 v[36:39], v228, s[60:63], s71 offen offset:64 nt
  buffer_load_dwordx4 v[40:43], v228, s[60:63], s71 offen offset:128 nt
  buffer_load_dwordx4 v[44:47], v228, s[60:63], s71 offen offset:192 nt
  buffer_load_dwordx4 v[48:51], v229, s[64:67], 0 offen offset:0 nt
  buffer_load_dwordx4 v[52:55], v229, s[64:67], 0 offen offset:1024 nt
  s_waitcnt vmcnt(9)
  buffer_load_dwordx4 v[56:59], v229, s[64:67], 0 offen offset:2048 nt
  s_waitcnt vmcnt(9)
  buffer_load_dwordx4 v[60:63], v229, s[64:67], 0 offen offset:3072 nt
  s_waitcnt vmcnt(9)
  buffer_load_dwordx4 v[64:67], v229, s[64:67], s71 offen offset:0 nt
  s_waitcnt vmcnt(9)
  buffer_load_dwordx4 v[68:71], v229, s[64:67], s71 offen offset:1024 nt
  s_waitcnt vmcnt(9)
  buffer_load_dwordx4 v[72:75], v229, s[64:67], s71 offen offset:2048 nt
  s_waitcnt vmcnt(9)
  buffer_load_dwordx4 v[76:79], v229, s[64:67], s71 offen offset:3072 nt
  v_mov_b32 v7, 7168
  v_mov_b32 v8, 1
  s_mov_b64 exec, 1
  ds_add_u32 v7, v8 offset:20
  s_mov_b64 exec, -1
  s_waitcnt lgkmcnt(0)
  s_add_u32 s26, s26, 1
  s_lshl_b32 s72, s88, 14
  s_lshl_b32 s76, s86, 11
  s_add_u32 s72, s72, s76
  s_lshl_b32 s76, s3, 8
  s_add_u32 s72, s72, s76
  s_add_u32 s72, s72, 2097152
  s_lshl_b32 s76, s3, 7
  v_lshlrev_b32 v6, 2, v1
  v_add_u32 v6, s76, v6
K_SPL:
  s_mov_b32 s74, 0x100000
K_SP:
  s_load_dwordx16 s[4:19], s[24:25], s72 offset:0 glc
  s_load_dwordx16 s[28:43], s[24:25], s72 offset:64 glc
  s_load_dwordx16 s[44:59], s[24:25], s72 offset:128 glc
  s_load_dwordx16 s[80:95], s[24:25], s72 offset:192 glc
  s_waitcnt lgkmcnt(0)
  s_and_b64 s[76:77], s[4:5], s[6:7]
  s_or_b64 s[78:79], s[4:5], s[6:7]
  s_and_b64 s[76:77], s[76:77], s[8:9]
  s_or_b64 s[78:79], s[78:79], s[8:9]
  s_and_b64 s[76:77], s[76:77], s[10:11]
  s_or_b64 s[78:79], s[78:79], s[10:11]
  s_and_b64 s[76:77], s[76:77], s[12:13]
  s_or_b64 s[78:79], s[78:79], s[12:13]
  s_and_b64 s[76:77], s[76:77], s[14:15]
  s_or_b64 s[78:79], s[78:79], s[14:15]
  s_and_b64 s[76:77], s[76:77], s[16:17]
  s_or_b64 s[78:79], s[78:79], s[16:17]
  s_and_b64 s[76:77], s[76:77], s[18:19]
  s_or_b64 s[78:79], s[78:79], s[18:19]
  s_and_b64 s[76:77], s[76:77], s[28:29]
  s_or_b64 s[78:79], s[78:79], s[28:29]
  s_and_b64 s[76:77], s[76:77], s[30:31]
  s_or_b64 s[78:79], s[78:79], s[30:31]
  s_and_b64 s[76:77], s[76:77], s[32:33]
  s_or_b64 s[78:79], s[78:79], s[32:33]
  s_and_b64 s[76:77], s[76:77], s[34:35]
  s_or_b64 s[78:79], s[78:79], s[34:35]
  s_and_b64 s[76:77], s[76:77], s[36:37]
  s_or_b64 s[78:79], s[78:79], s[36:37]
  s_and_b64 s[76:77], s[76:77], s[38:39]
  s_or_b64 s[78:79], s[78:79], s[38:39]
  s_and_b64 s[76:77], s[76:77], s[40:41]
  s_or_b64 s[78:79], s[78:79], s[40:41]
  s_and_b64 s[76:77], s[76:77], s[42:43]
  s_or_b64 s[78:79], s[78:79], s[42:43]
  s_and_b64 s[76:77], s[76:77], s[44:45]
  s_or_b64 s[78:79], s[78:79], s[44:45]
  s_and_b64 s[76:77], s[76:77], s[46:47]
  s_or_b64 s[78:79], s[78:79], s[46:47]
  s_and_b64 s[76:77], s[76:77], s[48:49]
  s_or_b64 s[78:79], s[78:79], s[48:49]
  s_and_b64 s[76:77], s[76:77], s[50:51]
  s_or_b64 s[78:79], s[78:79], s[50:51]
  s_and_b64 s[76:77], s[76:77], s[52:53]
  s_or_b64 s[78:79], s[78:79], s[52:53]
  s_and_b64 s[76:77], s[76:77], s[54:55]
  s_or_b64 s[78:79], s[78:79], s[54:55]
  s_and_b64 s[76:77], s[76:77], s[56:57]
  s_or_b64 s[78:79], s[78:79], s[56:57]
  s_and_b64 s[76:77], s[76:77], s[58:59]
  s_or_b64 s[78:79], s[78:79], s[58:59]
  s_and_b64 s[76:77], s[76:77], s[80:81]
  s_or_b64 s[78:79], s[78:79], s[80:81]
  s_and_b64 s[76:77], s[76:77], s[82:83]
  s_or_b64 s[78:79], s[78:79], s[82:83]
  s_and_b64 s[76:77], s[76:77], s[84:85]
  s_or_b64 s[78:79], s[78:79], s[84:85]
  s_and_b64 s[76:77], s[76:77], s[86:87]
  s_or_b64 s[78:79], s[78:79], s[86:87]
  s_and_b64 s[76:77], s[76:77], s[88:89]
  s_or_b64 s[78:79], s[78:79], s[88:89]
  s_and_b64 s[76:77], s[76:77], s[90:91]
  s_or_b64 s[78:79], s[78:79], s[90:91]
  s_and_b64 s[76:77], s[76:77], s[92:93]
  s_or_b64 s[78:79], s[78:79], s[92:93]
  s_and_b64 s[76:77], s[76:77], s[94:95]
  s_or_b64 s[78:79], s[78:79], s[94:95]
  s_xor_b32 s77, s77, s26
  s_xor_b32 s79, s79, s26
  s_or_b32 s77, s77, s79
  s_cmp_eq_u32 s77, 0
  s_cbranch_scc1 K_SPD
  s_sub_u32 s74, s74, 1
  s_cmp_lg_u32 s74, 0
  s_cbranch_scc1 K_SP
K_SPD:
  v_writelane_b32 v5, s4, 0
  v_writelane_b32 v5, s6, 1
  v_writelane_b32 v5, s8, 2
  v_writelane_b32 v5, s10, 3
  v_writelane_b32 v5, s12, 4
  v_writelane_b32 v5, s14, 5
  v_writelane_b32 v5, s16, 6
  v_writelane_b32 v5, s18, 7
  v_writelane_b32 v5, s28, 8
  v_writelane_b32 v5, s30, 9
  v_writelane_b32 v5, s32, 10
  v_writelane_b32 v5, s34, 11
  v_writelane_b32 v5, s36, 12
  v_writelane_b32 v5, s38, 13
  v_writelane_b32 v5, s40, 14
  v_writelane_b32 v5, s42, 15
  v_writelane_b32 v5, s44, 16
  v_writelane_b32 v5, s46, 17
  v_writelane_b32 v5, s48, 18
  v_writelane_b32 v5, s50, 19
  v_writelane_b32 v5, s52, 20
  v_writelane_b32 v5, s54, 21
  v_writelane_b32 v5, s56, 22
  v_writelane_b32 v5, s58, 23
  v_writelane_b32 v5, s80, 24
  v_writelane_b32 v5, s82, 25
  v_writelane_b32 v5, s84, 26
  v_writelane_b32 v5, s86, 27
  v_writelane_b32 v5, s88, 28
  v_writelane_b32 v5, s90, 29
  v_writelane_b32 v5, s92, 30
  v_writelane_b32 v5, s94, 31
  s_mov_b64 exec, 0xffffffff
  ds_write_b32 v6, v5 offset:5632
  s_mov_b64 exec, 1
  ds_add_u32 v7, v8 offset:24
  s_mov_b64 exec, -1
K_QR:
  s_mov_b32 s74, 0x100000
K_QRL:
  ds_read_b32 v6, v7 offset:24
  s_waitcnt lgkmcnt(0)
  v_readfirstlane_b32 s75, v6
  s_cmp_ge_u32 s75, 9
  s_cbranch_scc1 K_QRD
  s_sub_u32 s74, s74, 1
  s_cmp_lg_u32 s74, 0
  s_cbranch_scc1 K_QRL
K_QRD:
K_B3:
  s_load_dwordx16 s[4:19], s[0:1], 0
  s_load_dwordx2 s[96:97], s[0:1], 64
  v_and_b32 v5, 3, v3
  v_lshlrev_b32 v5, 8, v5
  v_lshl_add_u32 v5, v4, 4, v5
  ds_read_b128 v[176:179], v5 offset:5632
  ds_read_b128 v[180:183], v5 offset:5696
  ds_read_b128 v[184:187], v5 offset:5760
  ds_read_b128 v[188:191], v5 offset:5824
  s_and_b32 s86, s2, 7
  s_lshr_b32 s87, s2, 3
  s_and_b32 s83, s87, 7
  s_lshl_b32 s84, s86, 5
  s_add_u32 s84, s84, s87
  s_lshr_b32 s85, s87, 3
  s_lshl_b32 s85, s85, 6
  s_lshl_b32 s74, s86, 3
  s_add_u32 s85, s85, s74
  s_add_u32 s85, s85, s83
  s_lshr_b32 s88, s87, 4
  s_and_b32 s89, s87, 15
  s_and_b32 s90, s2, 7
  s_lshr_b32 s91, s87, 3
  s_lshl_b32 s74, s86, 2
  s_add_u32 s91, s91, s74
  s_lshr_b32 s88, s2, 7
  s_lshr_b32 s86, s2, 4
  s_and_b32 s86, s86, 7
  s_and_b32 s89, s2, 15
  s_and_b32 s75, s2, 63
  s_lshr_b32 s76, s2, 6
  s_lshr_b32 s74, s75, 2
  s_lshr_b32 s88, s74, 3
  s_and_b32 s86, s74, 7
  s_and_b32 s77, s75, 3
  s_lshl_b32 s89, s77, 2
  s_add_u32 s89, s89, s76
  s_lshl_b32 s93, s88, 3
  s_add_u32 s93, s93, s86
  s_mul_i32 s93, s93, 4
  s_and_b32 s74, s3, 3
  s_add_u32 s93, s93, s74
  s_lshl_b32 s93, s93, 8
  s_add_u32 s93, s93, 3145728
  s_mul_i32 s92, s74, 0
  s_add_u32 s92, s92, 1024
  s_mul_i32 s94, s89, 64
  s_mov_b32 s95, 0
  s_lshr_b32 s94, s89, 2
  s_lshl_b32 s94, s94, 8
  s_and_b32 s76, s89, 3
  s_lshl_b32 s76, s76, 2
  s_add_u32 s94, s94, s76
  s_and_b32 s75, s2, 63
  s_mul_i32 s95, s75, 1
  v_mov_b32 v144, 0
  v_mov_b32 v145, 0
  v_mov_b32 v146, 0
  v_mov_b32 v147, 0
  v_mov_b32 v148, 0
  v_mov_b32 v149, 0
  v_mov_b32 v150, 0
  v_mov_b32 v151, 0
  v_mov_b32 v152, 0
  v_mov_b32 v153, 0
  v_mov_b32 v154, 0
  v_mov_b32 v155, 0
  v_mov_b32 v156, 0
  v_mov_b32 v157, 0
  v_mov_b32 v158, 0
  v_mov_b32 v159, 0
  v_mov_b32 v160, 0
  v_mov_b32 v161, 0
  v_mov_b32 v162, 0
  v_mov_b32 v163, 0
  v_mov_b32 v164, 0
  v_mov_b32 v165, 0
  v_mov_b32 v166, 0
  v_mov_b32 v167, 0
  v_mov_b32 v168, 0
  v_mov_b32 v169, 0
  v_mov_b32 v170, 0
  v_mov_b32 v171, 0
  v_mov_b32 v172, 0
  v_mov_b32 v173, 0
  v_mov_b32 v174, 0
  v_mov_b32 v175, 0
  v_mov_b32 v236, 0xf149f2ca
  v_mov_b32 v237, 0
  v_mov_b32 v7, 7168
  v_mov_b32 v8, 1
  s_waitcnt lgkmcnt(0)
  s_mov_b32 s28, s4
  s_and_b32 s29, s5, 0xffff
  s_mov_b32 s30, 2048
  s_mov_b32 s31, 0x00020000
  s_mov_b32 s44, s16
  s_and_b32 s45, s17, 0xffff
  s_mov_b32 s46, 1835008
  s_mov_b32 s47, 0x00020000
  s_mov_b32 s48, s12
  s_and_b32 s49, s13, 0xffff
  s_mov_b32 s50, 4194304
  s_mov_b32 s51, 0x00020000
  s_mov_b32 s52, s18
  s_and_b32 s53, s19, 0xffff
  s_mov_b32 s54, 1835008
  s_mov_b32 s55, 0x00020000
  s_mov_b32 s32, s96
  s_and_b32 s33, s97, 0xffff
  s_mov_b32 s34, 2048
  s_mov_b32 s35, 0x00020000
  s_mov_b32 s27, 2
K_LOOP:
  s_mov_b64 exec, 1
  ds_add_rtn_u32 v9, v7, v8
  s_mov_b64 exec, -1
  s_waitcnt lgkmcnt(0)
  v_readfirstlane_b32 s73, v9
  s_mov_b32 s38, 0
  s_cmp_lg_u32 s27, 5
  s_cbranch_scc1 K_WA
  s_mov_b32 s27, 0
  s_mov_b32 s38, 1
K_WA:
  s_cmp_eq_u32 s27, 1
  s_cbranch_scc1 K_WX
  s_cmp_eq_u32 s38, 0
  s_cbranch_scc1 K_W0
  s_waitcnt vmcnt(9)
  s_branch K_W1
K_WX:
  s_cmp_ge_u32 s2, 224
  s_cbranch_scc1 K_W3
  s_waitcnt vmcnt(12)
  s_branch K_W1
K_W3:
  s_waitcnt vmcnt(11)
  s_branch K_W1
K_W0:
  s_waitcnt vmcnt(8)
K_W1:
  v_mfma_f32_16x16x32_bf16 v[192:195], v[16:19], v[176:179], 0
  v_mfma_f32_16x16x32_bf16 v[192:195], v[20:23], v[180:183], v[192:195]
  v_mfma_f32_16x16x32_bf16 v[192:195], v[24:27], v[184:187], v[192:195]
  v_mfma_f32_16x16x32_bf16 v[192:195], v[28:31], v[188:191], v[192:195]
  v_mfma_f32_16x16x32_bf16 v[196:199], v[32:35], v[176:179], 0
  v_mfma_f32_16x16x32_bf16 v[196:199], v[36:39], v[180:183], v[196:199]
  v_mfma_f32_16x16x32_bf16 v[196:199], v[40:43], v[184:187], v[196:199]
  v_mfma_f32_16x16x32_bf16 v[196:199], v[44:47], v[188:191], v[196:199]
  s_cmp_ge_u32 s73, 64
  s_cbranch_scc1 K_NK
  s_lshr_b32 s75, s73, 2
  s_add_u32 s75, s75, s95
  s_and_b32 s75, s75, 15
  s_lshl_b32 s75, s75, 4
  s_and_b32 s76, s73, 3
  s_add_u32 s75, s75, s76
  s_add_u32 s72, s75, s94
  s_lshl_b32 s75, s72, 13
  v_add_u32 v5, s75, v242
  v_add_u32 v6, s75, v243
  s_mov_b32 s74, 0x100000
K_FK:
  ds_read_b32 v9, v7 offset:8
  s_waitcnt lgkmcnt(0)
  v_readfirstlane_b32 s75, v9
  s_cmp_ge_u32 s75, s73
  s_cbranch_scc1 K_FKD
  s_sleep 1
  s_sub_u32 s74, s74, 1
  s_cmp_lg_u32 s74, 0
  s_cbranch_scc1 K_FK
K_FKD:
  buffer_load_dwordx4 v[16:19], v5, s[60:63], 0 offen offset:0 nt
  buffer_load_dwordx4 v[20:23], v5, s[60:63], 0 offen offset:64 nt
  buffer_load_dwordx4 v[24:27], v5, s[60:63], 0 offen offset:128 nt
  buffer_load_dwordx4 v[28:31], v5, s[60:63], 0 offen offset:192 nt
  buffer_load_dwordx4 v[32:35], v5, s[60:63], s71 offen offset:0 nt
  buffer_load_dwordx4 v[36:39], v5, s[60:63], s71 offen offset:64 nt
  buffer_load_dwordx4 v[40:43], v5, s[60:63], s71 offen offset:128 nt
  buffer_load_dwordx4 v[44:47], v5, s[60:63], s71 offen offset:192 nt
  s_mov_b64 exec, 1
  ds_add_u32 v7, v8 offset:8
  s_mov_b64 exec, -1
K_NK:
  s_nop 7
  s_nop 0
  v_max3_f32 v238, v192, v193, v194
  v_max3_f32 v239, v195, v196, v197
  v_max3_f32 v238, v238, v198, v199
  v_max_f32 v238, v238, v239
  v_mov_b32 v239, v238
  s_nop 1
  v_permlane16_swap_b32 v238, v239
  s_nop 1
  v_max_f32 v238, v238, v239
  v_mov_b32 v239, v238
  s_nop 1
  v_permlane32_swap_b32 v238, v239
  s_nop 1
  v_max3_f32 v238, v238, v239, v236
  v_sub_f32 v240, v236, v238
  v_mul_f32 v240, s68, v240
  v_exp_f32 v240, v240
  v_mov_b32 v236, v238
  v_mul_f32 v241, s68, v238
  v_fma_f32 v192, v192, s68, -v241
  v_fma_f32 v193, v193, s68, -v241
  v_fma_f32 v194, v194, s68, -v241
  v_fma_f32 v195, v195, s68, -v241
  v_fma_f32 v196, v196, s68, -v241
  v_fma_f32 v197, v197, s68, -v241
  v_fma_f32 v198, v198, s68, -v241
  v_fma_f32 v199, v199, s68, -v241
  v_exp_f32 v192, v192
  v_exp_f32 v193, v193
  v_exp_f32 v194, v194
  v_exp_f32 v195, v195
  v_exp_f32 v196, v196
  v_exp_f32 v197, v197
  v_exp_f32 v198, v198
  v_exp_f32 v199, v199
  s_nop 0
  v_mul_f32 v237, v237, v240
  v_add_f32 v237, v237, v192
  v_add_f32 v237, v237, v193
  v_add_f32 v237, v237, v194
  v_add_f32 v237, v237, v195
  v_add_f32 v237, v237, v196
  v_add_f32 v237, v237, v197
  v_add_f32 v237, v237, v198
  v_add_f32 v237, v237, v199
  v_cvt_pk_bf16_f32 v200, v192, v193
  v_cvt_pk_bf16_f32 v201, v194, v195
  v_cvt_pk_bf16_f32 v202, v196, v197
  v_cvt_pk_bf16_f32 v203, v198, v199
  v_mul_f32 v144, v144, v240
  v_mul_f32 v145, v145, v240
  v_mul_f32 v146, v146, v240
  v_mul_f32 v147, v147, v240
  v_mul_f32 v148, v148, v240
  v_mul_f32 v149, v149, v240
  v_mul_f32 v150, v150, v240
  v_mul_f32 v151, v151, v240
  v_mul_f32 v152, v152, v240
  v_mul_f32 v153, v153, v240
  v_mul_f32 v154, v154, v240
  v_mul_f32 v155, v155, v240
  v_mul_f32 v156, v156, v240
  v_mul_f32 v157, v157, v240
  v_mul_f32 v158, v158, v240
  v_mul_f32 v159, v159, v240
  v_mul_f32 v160, v160, v240
  v_mul_f32 v161, v161, v240
  v_mul_f32 v162, v162, v240
  v_mul_f32 v163, v163, v240
  v_mul_f32 v164, v164, v240
  v_mul_f32 v165, v165, v240
  v_mul_f32 v166, v166, v240
  v_mul_f32 v167, v167, v240
  v_mul_f32 v168, v168, v240
  v_mul_f32 v169, v169, v240
  v_mul_f32 v170, v170, v240
  v_mul_f32 v171, v171, v240
  v_mul_f32 v172, v172, v240
  v_mul_f32 v173, v173, v240
  v_mul_f32 v174, v174, v240
  v_mul_f32 v175, v175, v240
  s_cmp_lt_u32 s73, 64
  s_cbranch_scc1 K_W8
  s_waitcnt vmcnt(0)
K_W8:
  s_waitcnt vmcnt(8)
  v_perm_b32 v204, v52, v48, s69
  v_perm_b32 v205, v60, v56, s69
  v_perm_b32 v206, v68, v64, s69
  v_perm_b32 v207, v76, v72, s69
  v_perm_b32 v208, v52, v48, s70
  v_perm_b32 v209, v60, v56, s70
  v_perm_b32 v210, v68, v64, s70
  v_perm_b32 v211, v76, v72, s70
  v_perm_b32 v212, v53, v49, s69
  v_perm_b32 v213, v61, v57, s69
  v_perm_b32 v214, v69, v65, s69
  v_perm_b32 v215, v77, v73, s69
  v_perm_b32 v216, v53, v49, s70
  v_perm_b32 v217, v61, v57, s70
  v_perm_b32 v218, v69, v65, s70
  v_perm_b32 v219, v77, v73, s70
  v_perm_b32 v220, v54, v50, s69
  v_perm_b32 v221, v62, v58, s69
  v_perm_b32 v222, v70, v66, s69
  v_perm_b32 v223, v78, v74, s69
  v_perm_b32 v224, v54, v50, s70
  v_perm_b32 v225, v62, v58, s70
  v_perm_b32 v226, v70, v66, s70
  v_perm_b32 v227, v78, v74, s70
  v_perm_b32 v228, v55, v51, s69
  v_perm_b32 v229, v63, v59, s69
  v_perm_b32 v230, v71, v67, s69
  v_perm_b32 v231, v79, v75, s69
  v_perm_b32 v232, v55, v51, s70
  v_perm_b32 v233, v63, v59, s70
  v_perm_b32 v234, v71, v67, s70
  v_perm_b32 v235, v79, v75, s70
  s_nop 1
  v_mfma_f32_16x16x32_bf16 v[144:147], v[204:207], v[200:203], v[144:147]
  v_mfma_f32_16x16x32_bf16 v[148:151], v[208:211], v[200:203], v[148:151]
  v_mfma_f32_16x16x32_bf16 v[152:155], v[212:215], v[200:203], v[152:155]
  v_mfma_f32_16x16x32_bf16 v[156:159], v[216:219], v[200:203], v[156:159]
  v_mfma_f32_16x16x32_bf16 v[160:163], v[220:223], v[200:203], v[160:163]
  v_mfma_f32_16x16x32_bf16 v[164:167], v[224:227], v[200:203], v[164:167]
  v_mfma_f32_16x16x32_bf16 v[168:171], v[228:231], v[200:203], v[168:171]
  v_mfma_f32_16x16x32_bf16 v[172:175], v[232:235], v[200:203], v[172:175]
  s_cmp_ge_u32 s73, 64
  s_cbranch_scc1 K_NV
  s_mov_b32 s74, 0x100000
K_FV:
  ds_read_b32 v9, v7 offset:12
  s_waitcnt lgkmcnt(0)
  v_readfirstlane_b32 s75, v9
  s_cmp_ge_u32 s75, s73
  s_cbranch_scc1 K_FVD
  s_sleep 1
  s_sub_u32 s74, s74, 1
  s_cmp_lg_u32 s74, 0
  s_cbranch_scc1 K_FV
K_FVD:
  buffer_load_dwordx4 v[48:51], v6, s[64:67], 0 offen offset:0 nt
  buffer_load_dwordx4 v[52:55], v6, s[64:67], 0 offen offset:1024 nt
  buffer_load_dwordx4 v[56:59], v6, s[64:67], 0 offen offset:2048 nt
  buffer_load_dwordx4 v[60:63], v6, s[64:67], 0 offen offset:3072 nt
  buffer_load_dwordx4 v[64:67], v6, s[64:67], s71 offen offset:0 nt
  buffer_load_dwordx4 v[68:71], v6, s[64:67], s71 offen offset:1024 nt
  buffer_load_dwordx4 v[72:75], v6, s[64:67], s71 offen offset:2048 nt
  buffer_load_dwordx4 v[76:79], v6, s[64:67], s71 offen offset:3072 nt
  s_mov_b64 exec, 1
  ds_add_u32 v7, v8 offset:12
  s_mov_b64 exec, -1
K_NV:
  s_cmp_lg_u32 s27, 2
  s_cbranch_scc1 K_XLL
  s_mov_b32 s27, 3
  v_lshlrev_b32 v14, 10, v12
  v_lshl_add_u32 v14, v13, 4, v14
  s_cmp_ge_u32 s2, 224
  s_cbranch_scc1 K_XWL
  s_movk_i32 s75, 3584
  v_mul_lo_u32 v11, v12, s75
  v_lshl_add_u32 v11, v13, 4, v11
  s_and_b32 s75, s2, 7
  s_mul_i32 s75, s75, 229376
  s_lshr_b32 s76, s2, 3
  s_lshl_b32 s76, s76, 7
  s_add_u32 s75, s75, s76
  buffer_load_dwordx4 v[244:247], v11, s[44:47], s75 offen
K_XWL:
  s_lshl_b32 s75, s91, 17
  s_lshl_b32 s76, s83, 7
  s_add_u32 s75, s75, s76
  buffer_load_dwordx4 v[80:83], v14, s[48:51], s75 offen
  s_add_u32 s75, s75, 0x10000
  buffer_load_dwordx4 v[84:87], v14, s[48:51], s75 offen
  s_lshr_b32 s75, s2, 3
  s_lshl_b32 s75, s75, 16
  v_add_u32 v15, s75, v14
  s_lshl_b32 s75, s90, 7
  v_add_u32 v15, s75, v15
  buffer_load_dwordx4 v[252:255], v15, s[52:55], 0 offen
K_XLL:
  s_cmp_eq_u32 s27, 0
  s_cbranch_scc1 K_HSKPL
  s_sub_u32 s27, s27, 2
  s_cmp_eq_u32 s27, 1
  s_cbranch_scc1 K_HSKPL
  s_mov_b32 s27, 0
  v_mul_u32_u24 v5, 144, v12
  v_lshl_add_u32 v5, v13, 4, v5
  ds_write_b128 v5, v[80:83] offset:43520
  ds_write_b128 v5, v[84:87] offset:52736
  s_cmp_ge_u32 s2, 224
  s_cbranch_scc1 K_HSKPL
  s_and_b32 s75, s2, 7
  s_lshl_b32 s75, s75, 8
  v_lshl_add_u32 v5, v12, 2, s75
  ds_read_b32 v204, v5 offset:0
  ds_read_b32 v205, v5 offset:2048
  s_waitcnt lgkmcnt(0)
  v_lshlrev_b32 v206, 16, v244
  v_and_b32 v207, 0xffff0000, v244
  v_mul_f32 v212, v206, v204
  v_mul_f32 v213, v207, v204
  v_mul_f32 v220, v206, v205
  v_mul_f32 v221, v207, v205
  v_lshlrev_b32 v206, 16, v245
  v_and_b32 v207, 0xffff0000, v245
  v_mul_f32 v214, v206, v204
  v_mul_f32 v215, v207, v204
  v_mul_f32 v222, v206, v205
  v_mul_f32 v223, v207, v205
  v_lshlrev_b32 v206, 16, v246
  v_and_b32 v207, 0xffff0000, v246
  v_mul_f32 v216, v206, v204
  v_mul_f32 v217, v207, v204
  v_mul_f32 v224, v206, v205
  v_mul_f32 v225, v207, v205
  v_lshlrev_b32 v206, 16, v247
  v_and_b32 v207, 0xffff0000, v247
  v_mul_f32 v218, v206, v204
  v_mul_f32 v219, v207, v204
  v_mul_f32 v226, v206, v205
  v_mul_f32 v227, v207, v205
  s_nop 1
  v_add_f32_dpp v212, v212, v212 row_ror:8 row_mask:0xf bank_mask:0xf
  v_add_f32_dpp v213, v213, v213 row_ror:8 row_mask:0xf bank_mask:0xf
  v_add_f32_dpp v214, v214, v214 row_ror:8 row_mask:0xf bank_mask:0xf
  v_add_f32_dpp v215, v215, v215 row_ror:8 row_mask:0xf bank_mask:0xf
  v_add_f32_dpp v216, v216, v216 row_ror:8 row_mask:0xf bank_mask:0xf
  v_add_f32_dpp v217, v217, v217 row_ror:8 row_mask:0xf bank_mask:0xf
  v_add_f32_dpp v218, v218, v218 row_ror:8 row_mask:0xf bank_mask:0xf
  v_add_f32_dpp v219, v219, v219 row_ror:8 row_mask:0xf bank_mask:0xf
  v_add_f32_dpp v220, v220, v220 row_ror:8 row_mask:0xf bank_mask:0xf
  v_add_f32_dpp v221, v221, v221 row_ror:8 row_mask:0xf bank_mask:0xf
  v_add_f32_dpp v222, v222, v222 row_ror:8 row_mask:0xf bank_mask:0xf
  v_add_f32_dpp v223, v223, v223 row_ror:8 row_mask:0xf bank_mask:0xf
  v_add_f32_dpp v224, v224, v224 row_ror:8 row_mask:0xf bank_mask:0xf
  v_add_f32_dpp v225, v225, v225 row_ror:8 row_mask:0xf bank_mask:0xf
  v_add_f32_dpp v226, v226, v226 row_ror:8 row_mask:0xf bank_mask:0xf
  v_add_f32_dpp v227, v227, v227 row_ror:8 row_mask:0xf bank_mask:0xf
  v_mov_b32 v228, v212
  v_mov_b32 v229, v213
  v_mov_b32 v230, v214
  v_mov_b32 v231, v215
  v_mov_b32 v232, v216
  v_mov_b32 v233, v217
  v_mov_b32 v234, v218
  v_mov_b32 v235, v219
  v_mov_b32 v204, v220
  v_mov_b32 v205, v221
  v_mov_b32 v206, v222
  v_mov_b32 v207, v223
  v_mov_b32 v208, v224
  v_mov_b32 v209, v225
  v_mov_b32 v210, v226
  v_mov_b32 v211, v227
  s_nop 1
  v_permlane16_swap_b32 v212, v228
  v_permlane16_swap_b32 v213, v229
  v_permlane16_swap_b32 v214, v230
  v_permlane16_swap_b32 v215, v231
  v_permlane16_swap_b32 v216, v232
  v_permlane16_swap_b32 v217, v233
  v_permlane16_swap_b32 v218, v234
  v_permlane16_swap_b32 v219, v235
  v_permlane16_swap_b32 v220, v204
  v_permlane16_swap_b32 v221, v205
  v_permlane16_swap_b32 v222, v206
  v_permlane16_swap_b32 v223, v207
  v_permlane16_swap_b32 v224, v208
  v_permlane16_swap_b32 v225, v209
  v_permlane16_swap_b32 v226, v210
  v_permlane16_swap_b32 v227, v211
  s_nop 1
  v_add_f32 v212, v212, v228
  v_add_f32 v213, v213, v229
  v_add_f32 v214, v214, v230
  v_add_f32 v215, v215, v231
  v_add_f32 v216, v216, v232
  v_add_f32 v217, v217, v233
  v_add_f32 v218, v218, v234
  v_add_f32 v219, v219, v235
  v_add_f32 v220, v220, v204
  v_add_f32 v221, v221, v205
  v_add_f32 v222, v222, v206
  v_add_f32 v223, v223, v207
  v_add_f32 v224, v224, v208
  v_add_f32 v225, v225, v209
  v_add_f32 v226, v226, v210
  v_add_f32 v227, v227, v211
  v_mov_b32 v228, v212
  v_mov_b32 v229, v213
  v_mov_b32 v230, v214
  v_mov_b32 v231, v215
  v_mov_b32 v232, v216
  v_mov_b32 v233, v217
  v_mov_b32 v234, v218
  v_mov_b32 v235, v219
  v_mov_b32 v204, v220
  v_mov_b32 v205, v221
  v_mov_b32 v206, v222
  v_mov_b32 v207, v223
  v_mov_b32 v208, v224
  v_mov_b32 v209, v225
  v_mov_b32 v210, v226
  v_mov_b32 v211, v227
  s_nop 1
  v_permlane32_swap_b32 v212, v228
  v_permlane32_swap_b32 v213, v229
  v_permlane32_swap_b32 v214, v230
  v_permlane32_swap_b32 v215, v231
  v_permlane32_swap_b32 v216, v232
  v_permlane32_swap_b32 v217, v233
  v_permlane32_swap_b32 v218, v234
  v_permlane32_swap_b32 v219, v235
  v_permlane32_swap_b32 v220, v204
  v_permlane32_swap_b32 v221, v205
  v_permlane32_swap_b32 v222, v206
  v_permlane32_swap_b32 v223, v207
  v_permlane32_swap_b32 v224, v208
  v_permlane32_swap_b32 v225, v209
  v_permlane32_swap_b32 v226, v210
  v_permlane32_swap_b32 v227, v211
  s_nop 1
  v_add_f32 v212, v212, v228
  v_add_f32 v213, v213, v229
  v_add_f32 v214, v214, v230
  v_add_f32 v215, v215, v231
  v_add_f32 v216, v216, v232
  v_add_f32 v217, v217, v233
  v_add_f32 v218, v218, v234
  v_add_f32 v219, v219, v235
  v_add_f32 v220, v220, v204
  v_add_f32 v221, v221, v205
  v_add_f32 v222, v222, v206
  v_add_f32 v223, v223, v207
  v_add_f32 v224, v224, v208
  v_add_f32 v225, v225, v209
  v_add_f32 v226, v226, v210
  v_add_f32 v227, v227, v211
  s_lshl_b32 s75, s3, 9
  v_lshlrev_b32 v5, 5, v1
  v_add_u32 v5, s75, v5
  s_mov_b64 exec, 0xff
  ds_write_b128 v5, v[212:215] offset:27136
  ds_write_b128 v5, v[216:219] offset:27152
  ds_write_b128 v5, v[220:223] offset:27392
  ds_write_b128 v5, v[224:227] offset:27408
  s_mov_b64 exec, 1
  ds_add_rtn_u32 v6, v7, v8 offset:4
  s_mov_b64 exec, -1
  s_waitcnt lgkmcnt(0)
  v_readfirstlane_b32 s75, v6
  s_cmp_lg_u32 s75, 7
  s_cbranch_scc1 K_HSKPL
  v_lshlrev_b32 v5, 2, v1
  ds_read_b32 v204, v5 offset:27136
  ds_read_b32 v205, v5 offset:27392
  ds_read_b32 v206, v5 offset:27648
  ds_read_b32 v207, v5 offset:27904
  ds_read_b32 v208, v5 offset:28160
  ds_read_b32 v209, v5 offset:28416
  ds_read_b32 v210, v5 offset:28672
  ds_read_b32 v211, v5 offset:28928
  ds_read_b32 v212, v5 offset:29184
  ds_read_b32 v213, v5 offset:29440
  ds_read_b32 v214, v5 offset:29696
  ds_read_b32 v215, v5 offset:29952
  ds_read_b32 v216, v5 offset:30208
  ds_read_b32 v217, v5 offset:30464
  ds_read_b32 v218, v5 offset:30720
  ds_read_b32 v219, v5 offset:30976
  v_lshlrev_b32 v6, 4, v1
  s_lshl_b32 s75, s2, 10
  s_mov_b32 s76, 0
  s_add_u32 s75, s75, s76
  s_add_u32 s75, s75, 10485760
  s_waitcnt lgkmcnt(0)
  v_pk_add_f32 v[204:205], v[204:205], v[206:207]
  v_pk_add_f32 v[208:209], v[208:209], v[210:211]
  v_pk_add_f32 v[212:213], v[212:213], v[214:215]
  v_pk_add_f32 v[216:217], v[216:217], v[218:219]
  v_pk_add_f32 v[204:205], v[204:205], v[208:209]
  v_pk_add_f32 v[212:213], v[212:213], v[216:217]
  v_pk_add_f32 v[204:205], v[204:205], v[212:213]
  v_mov_b32 v206, s26
  v_mov_b32 v207, s26
  buffer_store_dwordx4 v[204:207], v6, s[20:23], s75 offen sc1
  s_mov_b32 s27, 5
K_HSKPL:
  s_cmp_lt_u32 s73, 64
  s_cbranch_scc1 K_LOOP
K_EXIT:
  s_cmp_eq_u32 s27, 0
  s_cbranch_scc1 K_X0
  s_cmp_eq_u32 s27, 5
  s_cbranch_scc1 K_X0
  s_cmp_lg_u32 s27, 2
  s_cbranch_scc1 K_XLE
  s_mov_b32 s27, 3
  v_lshlrev_b32 v14, 10, v12
  v_lshl_add_u32 v14, v13, 4, v14
  s_cmp_ge_u32 s2, 224
  s_cbranch_scc1 K_XWE
  s_movk_i32 s75, 3584
  v_mul_lo_u32 v11, v12, s75
  v_lshl_add_u32 v11, v13, 4, v11
  s_and_b32 s75, s2, 7
  s_mul_i32 s75, s75, 229376
  s_lshr_b32 s76, s2, 3
  s_lshl_b32 s76, s76, 7
  s_add_u32 s75, s75, s76
  buffer_load_dwordx4 v[244:247], v11, s[44:47], s75 offen
K_XWE:
  s_lshl_b32 s75, s91, 17
  s_lshl_b32 s76, s83, 7
  s_add_u32 s75, s75, s76
  buffer_load_dwordx4 v[80:83], v14, s[48:51], s75 offen
  s_add_u32 s75, s75, 0x10000
  buffer_load_dwordx4 v[84:87], v14, s[48:51], s75 offen
  s_lshr_b32 s75, s2, 3
  s_lshl_b32 s75, s75, 16
  v_add_u32 v15, s75, v14
  s_lshl_b32 s75, s90, 7
  v_add_u32 v15, s75, v15
  buffer_load_dwordx4 v[252:255], v15, s[52:55], 0 offen
K_XLE:
  s_mov_b32 s27, 1
  s_waitcnt vmcnt(0)
  s_cmp_eq_u32 s27, 0
  s_cbranch_scc1 K_HSKPE
  s_sub_u32 s27, s27, 2
  s_cmp_eq_u32 s27, 1
  s_cbranch_scc1 K_HSKPE
  s_mov_b32 s27, 0
  v_mul_u32_u24 v5, 144, v12
  v_lshl_add_u32 v5, v13, 4, v5
  ds_write_b128 v5, v[80:83] offset:43520
  ds_write_b128 v5, v[84:87] offset:52736
  s_cmp_ge_u32 s2, 224
  s_cbranch_scc1 K_HSKPE
  s_and_b32 s75, s2, 7
  s_lshl_b32 s75, s75, 8
  v_lshl_add_u32 v5, v12, 2, s75
  ds_read_b32 v204, v5 offset:0
  ds_read_b32 v205, v5 offset:2048
  s_waitcnt lgkmcnt(0)
  v_lshlrev_b32 v206, 16, v244
  v_and_b32 v207, 0xffff0000, v244
  v_mul_f32 v212, v206, v204
  v_mul_f32 v213, v207, v204
  v_mul_f32 v220, v206, v205
  v_mul_f32 v221, v207, v205
  v_lshlrev_b32 v206, 16, v245
  v_and_b32 v207, 0xffff0000, v245
  v_mul_f32 v214, v206, v204
  v_mul_f32 v215, v207, v204
  v_mul_f32 v222, v206, v205
  v_mul_f32 v223, v207, v205
  v_lshlrev_b32 v206, 16, v246
  v_and_b32 v207, 0xffff0000, v246
  v_mul_f32 v216, v206, v204
  v_mul_f32 v217, v207, v204
  v_mul_f32 v224, v206, v205
  v_mul_f32 v225, v207, v205
  v_lshlrev_b32 v206, 16, v247
  v_and_b32 v207, 0xffff0000, v247
  v_mul_f32 v218, v206, v204
  v_mul_f32 v219, v207, v204
  v_mul_f32 v226, v206, v205
  v_mul_f32 v227, v207, v205
  s_nop 1
  v_add_f32_dpp v212, v212, v212 row_ror:8 row_mask:0xf bank_mask:0xf
  v_add_f32_dpp v213, v213, v213 row_ror:8 row_mask:0xf bank_mask:0xf
  v_add_f32_dpp v214, v214, v214 row_ror:8 row_mask:0xf bank_mask:0xf
  v_add_f32_dpp v215, v215, v215 row_ror:8 row_mask:0xf bank_mask:0xf
  v_add_f32_dpp v216, v216, v216 row_ror:8 row_mask:0xf bank_mask:0xf
  v_add_f32_dpp v217, v217, v217 row_ror:8 row_mask:0xf bank_mask:0xf
  v_add_f32_dpp v218, v218, v218 row_ror:8 row_mask:0xf bank_mask:0xf
  v_add_f32_dpp v219, v219, v219 row_ror:8 row_mask:0xf bank_mask:0xf
  v_add_f32_dpp v220, v220, v220 row_ror:8 row_mask:0xf bank_mask:0xf
  v_add_f32_dpp v221, v221, v221 row_ror:8 row_mask:0xf bank_mask:0xf
  v_add_f32_dpp v222, v222, v222 row_ror:8 row_mask:0xf bank_mask:0xf
  v_add_f32_dpp v223, v223, v223 row_ror:8 row_mask:0xf bank_mask:0xf
  v_add_f32_dpp v224, v224, v224 row_ror:8 row_mask:0xf bank_mask:0xf
  v_add_f32_dpp v225, v225, v225 row_ror:8 row_mask:0xf bank_mask:0xf
  v_add_f32_dpp v226, v226, v226 row_ror:8 row_mask:0xf bank_mask:0xf
  v_add_f32_dpp v227, v227, v227 row_ror:8 row_mask:0xf bank_mask:0xf
  v_mov_b32 v228, v212
  v_mov_b32 v229, v213
  v_mov_b32 v230, v214
  v_mov_b32 v231, v215
  v_mov_b32 v232, v216
  v_mov_b32 v233, v217
  v_mov_b32 v234, v218
  v_mov_b32 v235, v219
  v_mov_b32 v204, v220
  v_mov_b32 v205, v221
  v_mov_b32 v206, v222
  v_mov_b32 v207, v223
  v_mov_b32 v208, v224
  v_mov_b32 v209, v225
  v_mov_b32 v210, v226
  v_mov_b32 v211, v227
  s_nop 1
  v_permlane16_swap_b32 v212, v228
  v_permlane16_swap_b32 v213, v229
  v_permlane16_swap_b32 v214, v230
  v_permlane16_swap_b32 v215, v231
  v_permlane16_swap_b32 v216, v232
  v_permlane16_swap_b32 v217, v233
  v_permlane16_swap_b32 v218, v234
  v_permlane16_swap_b32 v219, v235
  v_permlane16_swap_b32 v220, v204
  v_permlane16_swap_b32 v221, v205
  v_permlane16_swap_b32 v222, v206
  v_permlane16_swap_b32 v223, v207
  v_permlane16_swap_b32 v224, v208
  v_permlane16_swap_b32 v225, v209
  v_permlane16_swap_b32 v226, v210
  v_permlane16_swap_b32 v227, v211
  s_nop 1
  v_add_f32 v212, v212, v228
  v_add_f32 v213, v213, v229
  v_add_f32 v214, v214, v230
  v_add_f32 v215, v215, v231
  v_add_f32 v216, v216, v232
  v_add_f32 v217, v217, v233
  v_add_f32 v218, v218, v234
  v_add_f32 v219, v219, v235
  v_add_f32 v220, v220, v204
  v_add_f32 v221, v221, v205
  v_add_f32 v222, v222, v206
  v_add_f32 v223, v223, v207
  v_add_f32 v224, v224, v208
  v_add_f32 v225, v225, v209
  v_add_f32 v226, v226, v210
  v_add_f32 v227, v227, v211
  v_mov_b32 v228, v212
  v_mov_b32 v229, v213
  v_mov_b32 v230, v214
  v_mov_b32 v231, v215
  v_mov_b32 v232, v216
  v_mov_b32 v233, v217
  v_mov_b32 v234, v218
  v_mov_b32 v235, v219
  v_mov_b32 v204, v220
  v_mov_b32 v205, v221
  v_mov_b32 v206, v222
  v_mov_b32 v207, v223
  v_mov_b32 v208, v224
  v_mov_b32 v209, v225
  v_mov_b32 v210, v226
  v_mov_b32 v211, v227
  s_nop 1
  v_permlane32_swap_b32 v212, v228
  v_permlane32_swap_b32 v213, v229
  v_permlane32_swap_b32 v214, v230
  v_permlane32_swap_b32 v215, v231
  v_permlane32_swap_b32 v216, v232
  v_permlane32_swap_b32 v217, v233
  v_permlane32_swap_b32 v218, v234
  v_permlane32_swap_b32 v219, v235
  v_permlane32_swap_b32 v220, v204
  v_permlane32_swap_b32 v221, v205
  v_permlane32_swap_b32 v222, v206
  v_permlane32_swap_b32 v223, v207
  v_permlane32_swap_b32 v224, v208
  v_permlane32_swap_b32 v225, v209
  v_permlane32_swap_b32 v226, v210
  v_permlane32_swap_b32 v227, v211
  s_nop 1
  v_add_f32 v212, v212, v228
  v_add_f32 v213, v213, v229
  v_add_f32 v214, v214, v230
  v_add_f32 v215, v215, v231
  v_add_f32 v216, v216, v232
  v_add_f32 v217, v217, v233
  v_add_f32 v218, v218, v234
  v_add_f32 v219, v219, v235
  v_add_f32 v220, v220, v204
  v_add_f32 v221, v221, v205
  v_add_f32 v222, v222, v206
  v_add_f32 v223, v223, v207
  v_add_f32 v224, v224, v208
  v_add_f32 v225, v225, v209
  v_add_f32 v226, v226, v210
  v_add_f32 v227, v227, v211
  s_lshl_b32 s75, s3, 9
  v_lshlrev_b32 v5, 5, v1
  v_add_u32 v5, s75, v5
  s_mov_b64 exec, 0xff
  ds_write_b128 v5, v[212:215] offset:27136
  ds_write_b128 v5, v[216:219] offset:27152
  ds_write_b128 v5, v[220:223] offset:27392
  ds_write_b128 v5, v[224:227] offset:27408
  s_mov_b64 exec, 1
  ds_add_rtn_u32 v6, v7, v8 offset:4
  s_mov_b64 exec, -1
  s_waitcnt lgkmcnt(0)
  v_readfirstlane_b32 s75, v6
  s_cmp_lg_u32 s75, 7
  s_cbranch_scc1 K_HSKPE
  v_lshlrev_b32 v5, 2, v1
  ds_read_b32 v204, v5 offset:27136
  ds_read_b32 v205, v5 offset:27392
  ds_read_b32 v206, v5 offset:27648
  ds_read_b32 v207, v5 offset:27904
  ds_read_b32 v208, v5 offset:28160
  ds_read_b32 v209, v5 offset:28416
  ds_read_b32 v210, v5 offset:28672
  ds_read_b32 v211, v5 offset:28928
  ds_read_b32 v212, v5 offset:29184
  ds_read_b32 v213, v5 offset:29440
  ds_read_b32 v214, v5 offset:29696
  ds_read_b32 v215, v5 offset:29952
  ds_read_b32 v216, v5 offset:30208
  ds_read_b32 v217, v5 offset:30464
  ds_read_b32 v218, v5 offset:30720
  ds_read_b32 v219, v5 offset:30976
  v_lshlrev_b32 v6, 4, v1
  s_lshl_b32 s75, s2, 10
  s_mov_b32 s76, 0
  s_add_u32 s75, s75, s76
  s_add_u32 s75, s75, 10485760
  s_waitcnt lgkmcnt(0)
  v_pk_add_f32 v[204:205], v[204:205], v[206:207]
  v_pk_add_f32 v[208:209], v[208:209], v[210:211]
  v_pk_add_f32 v[212:213], v[212:213], v[214:215]
  v_pk_add_f32 v[216:217], v[216:217], v[218:219]
  v_pk_add_f32 v[204:205], v[204:205], v[208:209]
  v_pk_add_f32 v[212:213], v[212:213], v[216:217]
  v_pk_add_f32 v[204:205], v[204:205], v[212:213]
  v_mov_b32 v206, s26
  v_mov_b32 v207, s26
  buffer_store_dwordx4 v[204:207], v6, s[20:23], s75 offen sc1
K_HSKPE:
K_X0:
  s_cmp_ge_u32 s2, 224
  s_cbranch_scc1 K_HSK
  v_lshlrev_b32 v248, 4, v12
  v_lshl_add_u32 v248, v13, 10, v248
  s_lshr_b32 s75, s2, 3
  s_lshl_b32 s75, s75, 13
  s_add_u32 s75, s75, 10485760
  v_add_u32 v248, s75, v248
  buffer_load_dwordx4 v[244:247], v248, s[20:23], 0 offen sc1
K_HSK:
  v_mov_b32 v239, v237
  s_nop 1
  v_permlane16_swap_b32 v237, v239
  s_nop 1
  v_add_f32 v237, v237, v239
  v_mov_b32 v239, v237
  s_nop 1
  v_permlane32_swap_b32 v237, v239
  s_nop 1
  v_add_f32 v237, v237, v239
  v_cmp_gt_u32 vcc, 4, v3
  s_and_saveexec_b64 s[78:79], vcc
  v_lshlrev_b32 v5, 4, v2
  v_lshl_add_u32 v5, v3, 2, v5
  v_add_u32 v5, v4, v5
  v_mul_u32_u24 v5, 144, v5
  s_nop 4
  ds_write_b128 v5, v[144:147] offset:8192
  ds_write_b128 v5, v[148:151] offset:8208
  ds_write_b128 v5, v[152:155] offset:8224
  ds_write_b128 v5, v[156:159] offset:8240
  ds_write_b128 v5, v[160:163] offset:8256
  ds_write_b128 v5, v[164:167] offset:8272
  ds_write_b128 v5, v[168:171] offset:8288
  ds_write_b128 v5, v[172:175] offset:8304
  v_cmp_gt_u32 vcc, 4, v1
  s_and_b64 exec, exec, vcc
  v_lshlrev_b32 v6, 5, v2
  v_lshl_add_u32 v6, v3, 3, v6
  ds_write_b32 v6, v236 offset:26624
  ds_write_b32 v6, v237 offset:26628
  s_mov_b64 exec, s[78:79]
  s_waitcnt lgkmcnt(0)
  s_barrier
  v_lshrrev_b32 v5, 7, v0
  v_and_b32 v6, 127, v0
  v_lshlrev_b32 v7, 3, v5
  ds_read_b64 v[160:161], v7 offset:26624
  ds_read_b64 v[162:163], v7 offset:26656
  ds_read_b64 v[164:165], v7 offset:26688
  ds_read_b64 v[166:167], v7 offset:26720
  ds_read_b64 v[168:169], v7 offset:26752
  ds_read_b64 v[170:171], v7 offset:26784
  ds_read_b64 v[172:173], v7 offset:26816
  ds_read_b64 v[174:175], v7 offset:26848
  v_lshrrev_b32 v8, 5, v0
  v_mul_u32_u24 v8, 144, v8
  v_and_b32 v9, 24, v0
  v_and_b32 v10, 1, v0
  v_lshl_add_u32 v9, v10, 2, v9
  v_bfe_u32 v10, v0, 1, 2
  v_add_u32 v9, v10, v9
  v_lshl_add_u32 v8, v9, 2, v8
  ds_read_b32 v176, v8 offset:8192
  ds_read_b32 v177, v8 offset:10496
  ds_read_b32 v178, v8 offset:12800
  ds_read_b32 v179, v8 offset:15104
  ds_read_b32 v180, v8 offset:17408
  ds_read_b32 v181, v8 offset:19712
  ds_read_b32 v182, v8 offset:22016
  ds_read_b32 v183, v8 offset:24320
  s_waitcnt lgkmcnt(0)
  v_max3_f32 v184, v160, v162, v164
  v_max3_f32 v185, v166, v168, v170
  v_max3_f32 v184, v184, v172, v174
  v_max_f32 v184, v184, v185
  v_mov_b32 v186, 0
  v_mov_b32 v187, 0
  v_sub_f32 v185, v160, v184
  v_mul_f32 v185, s68, v185
  v_exp_f32 v185, v185
  s_nop 0
  v_fmac_f32 v186, v185, v161
  v_fmac_f32 v187, v185, v176
  v_sub_f32 v185, v162, v184
  v_mul_f32 v185, s68, v185
  v_exp_f32 v185, v185
  s_nop 0
  v_fmac_f32 v186, v185, v163
  v_fmac_f32 v187, v185, v177
  v_sub_f32 v185, v164, v184
  v_mul_f32 v185, s68, v185
  v_exp_f32 v185, v185
  s_nop 0
  v_fmac_f32 v186, v185, v165
  v_fmac_f32 v187, v185, v178
  v_sub_f32 v185, v166, v184
  v_mul_f32 v185, s68, v185
  v_exp_f32 v185, v185
  s_nop 0
  v_fmac_f32 v186, v185, v167
  v_fmac_f32 v187, v185, v179
  v_sub_f32 v185, v168, v184
  v_mul_f32 v185, s68, v185
  v_exp_f32 v185, v185
  s_nop 0
  v_fmac_f32 v186, v185, v169
  v_fmac_f32 v187, v185, v180
  v_sub_f32 v185, v170, v184
  v_mul_f32 v185, s68, v185
  v_exp_f32 v185, v185
  s_nop 0
  v_fmac_f32 v186, v185, v171
  v_fmac_f32 v187, v185, v181
  v_sub_f32 v185, v172, v184
  v_mul_f32 v185, s68, v185
  v_exp_f32 v185, v185
  s_nop 0
  v_fmac_f32 v186, v185, v173
  v_fmac_f32 v187, v185, v182
  v_sub_f32 v185, v174, v184
  v_mul_f32 v185, s68, v185
  v_exp_f32 v185, v185
  s_nop 0
  v_fmac_f32 v186, v185, v175
  v_fmac_f32 v187, v185, v183
  s_lshl_b32 s75, s88, 5
  s_lshl_b32 s76, s86, 2
  s_add_u32 s75, s75, s76
  s_lshl_b32 s75, s75, 4
  s_add_u32 s75, s75, s89
  v_lshlrev_b32 v7, 4, v5
  v_add_u32 v7, s75, v7
  v_lshlrev_b32 v8, 10, v7
  v_lshl_add_u32 v8, v6, 3, v8
  s_mov_b32 s75, 5242880
  v_mov_b32 v188, v187
  v_mov_b32 v189, s26
  buffer_store_dwordx2 v[188:189], v8, s[20:23], s75 offen sc1
  v_cmp_eq_u32 vcc, 0, v6
  s_and_saveexec_b64 s[78:79], vcc
  v_lshlrev_b32 v7, 4, v7
  v_mov_b32 v185, v186
  v_mov_b32 v186, s26
  s_mov_b32 s75, 6291456
  buffer_store_dwordx3 v[184:186], v7, s[20:23], s75 offen sc1
  s_mov_b64 exec, s[78:79]
  s_cmp_ge_u32 s2, 224
  s_cbranch_scc1 K_T4
  s_mov_b32 s74, 0x100000
  s_waitcnt vmcnt(1)
K_HR:
  v_cmp_ne_u32 vcc, s26, v246
  v_cmp_ne_u32 s[78:79], s26, v247
  s_or_b64 vcc, vcc, s[78:79]
  s_cmp_eq_u64 vcc, 0
  s_cbranch_scc1 K_HOK
  buffer_load_dwordx4 v[244:247], v248, s[20:23], 0 offen sc1
  s_waitcnt vmcnt(0)
  s_sub_u32 s74, s74, 1
  s_cmp_lg_u32 s74, 0
  s_cbranch_scc1 K_HR
K_HOK:
  s_nop 1
  v_add_f32_dpp v244, v244, v244 quad_perm:[1,0,3,2] row_mask:0xf bank_mask:0xf
  v_add_f32_dpp v245, v245, v245 quad_perm:[1,0,3,2] row_mask:0xf bank_mask:0xf
  s_nop 1
  v_add_f32_dpp v244, v244, v244 quad_perm:[2,3,0,1] row_mask:0xf bank_mask:0xf
  v_add_f32_dpp v245, v245, v245 quad_perm:[2,3,0,1] row_mask:0xf bank_mask:0xf
  s_nop 1
  v_add_f32_dpp v244, v244, v244 row_half_mirror row_mask:0xf bank_mask:0xf
  v_add_f32_dpp v245, v245, v245 row_half_mirror row_mask:0xf bank_mask:0xf
  v_max_f32 v168, 0, v244
  v_max_f32 v169, 0, v245
  v_cvt_pk_bf16_f32 v168, v168, v168
  v_lshlrev_b32 v168, 16, v168
  v_cvt_pk_bf16_f32 v169, v169, v169
  v_lshlrev_b32 v169, 16, v169
  v_mov_b32 v180, 0
  v_mov_b32 v181, 0
  v_mov_b32 v182, 0
  v_mov_b32 v183, 0
  v_mov_b32 v184, 0
  v_mov_b32 v185, 0
  v_mov_b32 v186, 0
  v_mov_b32 v187, 0
  v_mov_b32 v188, 0
  v_mov_b32 v189, 0
  v_mov_b32 v190, 0
  v_mov_b32 v191, 0
  v_mov_b32 v192, 0
  v_mov_b32 v193, 0
  v_mov_b32 v194, 0
  v_mov_b32 v195, 0
  v_lshlrev_b32 v160, 16, v252
  v_and_b32 v161, 0xffff0000, v252
  v_fmac_f32 v180, v160, v168
  v_fmac_f32 v181, v161, v168
  v_fmac_f32 v188, v160, v169
  v_fmac_f32 v189, v161, v169
  v_lshlrev_b32 v160, 16, v253
  v_and_b32 v161, 0xffff0000, v253
  v_fmac_f32 v182, v160, v168
  v_fmac_f32 v183, v161, v168
  v_fmac_f32 v190, v160, v169
  v_fmac_f32 v191, v161, v169
  v_lshlrev_b32 v160, 16, v254
  v_and_b32 v161, 0xffff0000, v254
  v_fmac_f32 v184, v160, v168
  v_fmac_f32 v185, v161, v168
  v_fmac_f32 v192, v160, v169
  v_fmac_f32 v193, v161, v169
  v_lshlrev_b32 v160, 16, v255
  v_and_b32 v161, 0xffff0000, v255
  v_fmac_f32 v186, v160, v168
  v_fmac_f32 v187, v161, v168
  v_fmac_f32 v194, v160, v169
  v_fmac_f32 v195, v161, v169
  s_nop 1
  v_add_f32_dpp v180, v180, v180 row_ror:8 row_mask:0xf bank_mask:0xf
  v_add_f32_dpp v181, v181, v181 row_ror:8 row_mask:0xf bank_mask:0xf
  v_add_f32_dpp v182, v182, v182 row_ror:8 row_mask:0xf bank_mask:0xf
  v_add_f32_dpp v183, v183, v183 row_ror:8 row_mask:0xf bank_mask:0xf
  v_add_f32_dpp v184, v184, v184 row_ror:8 row_mask:0xf bank_mask:0xf
  v_add_f32_dpp v185, v185, v185 row_ror:8 row_mask:0xf bank_mask:0xf
  v_add_f32_dpp v186, v186, v186 row_ror:8 row_mask:0xf bank_mask:0xf
  v_add_f32_dpp v187, v187, v187 row_ror:8 row_mask:0xf bank_mask:0xf
  v_add_f32_dpp v188, v188, v188 row_ror:8 row_mask:0xf bank_mask:0xf
  v_add_f32_dpp v189, v189, v189 row_ror:8 row_mask:0xf bank_mask:0xf
  v_add_f32_dpp v190, v190, v190 row_ror:8 row_mask:0xf bank_mask:0xf
  v_add_f32_dpp v191, v191, v191 row_ror:8 row_mask:0xf bank_mask:0xf
  v_add_f32_dpp v192, v192, v192 row_ror:8 row_mask:0xf bank_mask:0xf
  v_add_f32_dpp v193, v193, v193 row_ror:8 row_mask:0xf bank_mask:0xf
  v_add_f32_dpp v194, v194, v194 row_ror:8 row_mask:0xf bank_mask:0xf
  v_add_f32_dpp v195, v195, v195 row_ror:8 row_mask:0xf bank_mask:0xf
  s_lshr_b32 s75, s2, 3
  s_lshl_b32 s75, s75, 13
  s_add_u32 s75, s75, 7340032
  v_lshlrev_b32 v5, 2, v2
  v_add_u32 v5, v5, v4
  v_lshlrev_b32 v5, 9, v5
  v_and_b32 v6, 7, v1
  v_lshl_add_u32 v5, v6, 5, v5
  v_and_b32 v6, 8, v1
  v_cmp_eq_u32 vcc, 0, v6
  s_and_saveexec_b64 s[78:79], vcc
  ds_write_b128 v5, v[180:183] offset:27136
  ds_write_b128 v5, v[184:187] offset:27152
  ds_write_b128 v5, v[188:191] offset:27392
  ds_write_b128 v5, v[192:195] offset:27408
  s_mov_b64 exec, s[78:79]
  s_waitcnt lgkmcnt(0)
  s_barrier
  s_cmp_ge_u32 s3, 2
  s_cbranch_scc1 K_T3B
  v_lshlrev_b32 v5, 2, v0
  ds_read_b32 v204, v5 offset:27136
  ds_read_b32 v205, v5 offset:27648
  ds_read_b32 v206, v5 offset:28160
  ds_read_b32 v207, v5 offset:28672
  ds_read_b32 v208, v5 offset:29184
  ds_read_b32 v209, v5 offset:29696
  ds_read_b32 v210, v5 offset:30208
  ds_read_b32 v211, v5 offset:30720
  ds_read_b32 v212, v5 offset:31232
  ds_read_b32 v213, v5 offset:31744
  ds_read_b32 v214, v5 offset:32256
  ds_read_b32 v215, v5 offset:32768
  ds_read_b32 v216, v5 offset:33280
  ds_read_b32 v217, v5 offset:33792
  ds_read_b32 v218, v5 offset:34304
  ds_read_b32 v219, v5 offset:34816
  ds_read_b32 v220, v5 offset:35328
  ds_read_b32 v221, v5 offset:35840
  ds_read_b32 v222, v5 offset:36352
  ds_read_b32 v223, v5 offset:36864
  ds_read_b32 v224, v5 offset:37376
  ds_read_b32 v225, v5 offset:37888
  ds_read_b32 v226, v5 offset:38400
  ds_read_b32 v227, v5 offset:38912
  ds_read_b32 v228, v5 offset:39424
  ds_read_b32 v229, v5 offset:39936
  ds_read_b32 v230, v5 offset:40448
  ds_read_b32 v231, v5 offset:40960
  ds_read_b32 v232, v5 offset:41472
  ds_read_b32 v233, v5 offset:41984
  ds_read_b32 v234, v5 offset:42496
  ds_read_b32 v235, v5 offset:43008
  s_waitcnt lgkmcnt(0)
  v_add_f32 v205, v205, v206
  v_add_f32 v207, v207, v208
  v_add_f32 v209, v209, v210
  v_add_f32 v211, v211, v212
  v_add_f32 v213, v213, v214
  v_add_f32 v215, v215, v216
  v_add_f32 v217, v217, v218
  v_add_f32 v219, v219, v220
  v_add_f32 v221, v221, v222
  v_add_f32 v223, v223, v224
  v_add_f32 v225, v225, v226
  v_add_f32 v227, v227, v228
  v_add_f32 v229, v229, v230
  v_add_f32 v231, v231, v232
  v_add_f32 v233, v233, v234
  v_add_f32 v204, v204, v235
  v_add_f32 v204, v204, v205
  v_add_f32 v204, v204, v207
  v_add_f32 v204, v204, v209
  v_add_f32 v204, v204, v211
  v_add_f32 v204, v204, v213
  v_add_f32 v204, v204, v215
  v_add_f32 v204, v204, v217
  v_add_f32 v204, v204, v219
  v_add_f32 v204, v204, v221
  v_add_f32 v204, v204, v223
  v_add_f32 v204, v204, v225
  v_add_f32 v204, v204, v227
  v_add_f32 v204, v204, v229
  v_add_f32 v204, v204, v231
  v_add_f32 v204, v204, v233
  v_lshlrev_b32 v5, 12, v2
  v_lshl_add_u32 v5, v1, 3, v5
  s_lshl_b32 s76, s90, 9
  s_add_u32 s75, s75, s76
  v_mov_b32 v205, s26
  buffer_store_dwordx2 v[204:205], v5, s[20:23], s75 offen sc1
K_T3B:
K_T4:
  s_cmp_ge_u32 s3, 4
  s_cbranch_scc1 T_NW
  s_and_b32 s75, s3, 1
  s_cmp_eq_u32 s75, 1
  s_cselect_b32 s75, s70, s69
  v_mul_u32_u24 v11, 1152, v4
  v_lshl_add_u32 v11, v3, 2, v11
  s_bfe_u32 s76, s3, 0x10001
  s_lshl_b32 s76, s76, 6
  v_add_u32 v11, s76, v11
  ds_read_b32 v80, v11 offset:43520
  ds_read_b32 v81, v11 offset:43664
  ds_read_b32 v82, v11 offset:43808
  ds_read_b32 v83, v11 offset:43952
  ds_read_b32 v84, v11 offset:44096
  ds_read_b32 v85, v11 offset:44240
  ds_read_b32 v86, v11 offset:44384
  ds_read_b32 v87, v11 offset:44528
  ds_read_b32 v88, v11 offset:48128
  ds_read_b32 v89, v11 offset:48272
  ds_read_b32 v90, v11 offset:48416
  ds_read_b32 v91, v11 offset:48560
  ds_read_b32 v92, v11 offset:48704
  ds_read_b32 v93, v11 offset:48848
  ds_read_b32 v94, v11 offset:48992
  ds_read_b32 v95, v11 offset:49136
  ds_read_b32 v96, v11 offset:52736
  ds_read_b32 v97, v11 offset:52880
  ds_read_b32 v98, v11 offset:53024
  ds_read_b32 v99, v11 offset:53168
  ds_read_b32 v100, v11 offset:53312
  ds_read_b32 v101, v11 offset:53456
  ds_read_b32 v102, v11 offset:53600
  ds_read_b32 v103, v11 offset:53744
  ds_read_b32 v104, v11 offset:57344
  ds_read_b32 v105, v11 offset:57488
  ds_read_b32 v106, v11 offset:57632
  ds_read_b32 v107, v11 offset:57776
  ds_read_b32 v108, v11 offset:57920
  ds_read_b32 v109, v11 offset:58064
  ds_read_b32 v110, v11 offset:58208
  ds_read_b32 v111, v11 offset:58352
  s_waitcnt lgkmcnt(0)
  v_perm_b32 v112, v81, v80, s75
  v_perm_b32 v113, v83, v82, s75
  v_perm_b32 v114, v85, v84, s75
  v_perm_b32 v115, v87, v86, s75
  v_perm_b32 v116, v89, v88, s75
  v_perm_b32 v117, v91, v90, s75
  v_perm_b32 v118, v93, v92, s75
  v_perm_b32 v119, v95, v94, s75
  v_perm_b32 v120, v97, v96, s75
  v_perm_b32 v121, v99, v98, s75
  v_perm_b32 v122, v101, v100, s75
  v_perm_b32 v123, v103, v102, s75
  v_perm_b32 v124, v105, v104, s75
  v_perm_b32 v125, v107, v106, s75
  v_perm_b32 v126, v109, v108, s75
  v_perm_b32 v127, v111, v110, s75
  v_and_b32 v11, 1, v3
  v_lshlrev_b32 v11, 8, v11
  v_lshl_add_u32 v11, v4, 4, v11
  v_and_b32 v12, 1, v4
  v_lshlrev_b32 v13, 12, v12
  v_lshl_add_u32 v13, v3, 4, v13
  s_bfe_u32 s75, s3, 0x10001
  s_lshl_b32 s75, s75, 8
  s_and_b32 s78, s3, 1
  s_lshl_b32 s78, s78, 3
  s_add_u32 s75, s75, s78
  s_lshl_b32 s78, s83, 9
  s_add_u32 s75, s75, s78
  s_lshl_b32 s78, s91, 13
  s_add_u32 s75, s75, s78
  s_add_u32 s75, s75, 6356992
  v_add_u32 v13, s75, v13
T_NW:
  v_and_b32 v5, 3, v1
  v_lshrrev_b32 v6, 2, v1
  s_lshr_b32 s75, s3, 2
  s_lshl_b32 s75, s75, 5
  s_add_u32 s75, s75, s91
  s_lshl_b32 s76, s75, 8
  v_lshlrev_b32 v9, 4, v6
  v_add_u32 v9, s76, v9
  s_lshl_b32 s76, s75, 14
  s_and_b32 s75, s3, 3
  s_lshl_b32 s75, s75, 8
  s_add_u32 s76, s76, s75
  v_lshlrev_b32 v10, 10, v6
  v_lshl_add_u32 v10, v5, 4, v10
  v_add_u32 v10, s76, v10
  s_not_b32 s75, s26
  v_mov_b32 v17, s75
  v_mov_b32 v19, s75
  v_mov_b32 v21, s75
  v_mov_b32 v23, s75
  v_mov_b32 v25, s75
  v_mov_b32 v27, s75
  v_mov_b32 v29, s75
  v_mov_b32 v31, s75
  v_mov_b32 v34, s75
  s_mov_b64 s[76:77], -1
  s_mov_b64 s[78:79], -1
  s_mov_b32 s72, 6291456
  s_mov_b32 s73, 5242880
  s_mov_b32 s74, 0x100000
  s_mov_b32 s84, 64
T_P:
  s_mov_b64 exec, s[76:77]
  s_cbranch_execz T_P1
  buffer_load_dwordx3 v[32:34], v9, s[20:23], s72 offen sc1
T_P1:
  s_or_b64 s[80:81], s[76:77], s[78:79]
  s_bcnt1_i32_b64 s75, s[80:81]
  s_andn2_b64 s[80:81], s[78:79], s[76:77]
  s_cmp_le_u32 s75, s84
  s_mov_b32 s84, 8
  s_cselect_b64 exec, s[78:79], s[80:81]
  s_cbranch_execz T_P2
  buffer_load_dwordx4 v[16:19], v10, s[20:23], s73 offen offset:0 sc1
  buffer_load_dwordx4 v[20:23], v10, s[20:23], s73 offen offset:64 sc1
  buffer_load_dwordx4 v[24:27], v10, s[20:23], s73 offen offset:128 sc1
  buffer_load_dwordx4 v[28:31], v10, s[20:23], s73 offen offset:192 sc1
T_P2:
  s_mov_b64 exec, -1
  s_waitcnt vmcnt(0)
  s_sleep 1
  v_cmp_ne_u32 s[76:77], s26, v34
  v_cmp_ne_u32 s[78:79], s26, v17
  v_cmp_ne_u32 vcc, s26, v19
  s_or_b64 s[78:79], s[78:79], vcc
  v_cmp_ne_u32 vcc, s26, v21
  s_or_b64 s[78:79], s[78:79], vcc
  v_cmp_ne_u32 vcc, s26, v23
  s_or_b64 s[78:79], s[78:79], vcc
  v_cmp_ne_u32 vcc, s26, v25
  s_or_b64 s[78:79], s[78:79], vcc
  v_cmp_ne_u32 vcc, s26, v27
  s_or_b64 s[78:79], s[78:79], vcc
  v_cmp_ne_u32 vcc, s26, v29
  s_or_b64 s[78:79], s[78:79], vcc
  v_cmp_ne_u32 vcc, s26, v31
  s_or_b64 s[78:79], s[78:79], vcc
  s_or_b64 s[80:81], s[76:77], s[78:79]
  s_cmp_eq_u64 s[80:81], 0
  s_cbranch_scc1 T_PD
  s_sub_u32 s74, s74, 1
  s_cmp_lg_u32 s74, 0
  s_cbranch_scc1 T_P
T_PD:
  s_waitcnt vmcnt(0)
  v_mov_b32 v35, v32
  s_nop 1
  v_max_f32_dpp v35, v35, v35 row_ror:4 row_mask:0xf bank_mask:0xf
  s_nop 1
  v_max_f32_dpp v35, v35, v35 row_ror:8 row_mask:0xf bank_mask:0xf
  v_mov_b32 v36, v35
  s_nop 1
  v_permlane16_swap_b32 v35, v36
  s_nop 1
  v_max_f32 v35, v35, v36
  v_mov_b32 v36, v35
  s_nop 1
  v_permlane32_swap_b32 v35, v36
  s_nop 1
  v_max_f32 v35, v35, v36
  v_sub_f32 v32, v32, v35
  v_mul_f32 v32, s68, v32
  v_exp_f32 v32, v32
  s_nop 0
  v_mul_f32 v33, v33, v32
  v_mul_f32 v16, v16, v32
  v_mul_f32 v18, v18, v32
  v_mul_f32 v20, v20, v32
  v_mul_f32 v22, v22, v32
  v_mul_f32 v24, v24, v32
  v_mul_f32 v26, v26, v32
  v_mul_f32 v28, v28, v32
  v_mul_f32 v30, v30, v32
  s_nop 1
  v_add_f32_dpp v33, v33, v33 row_ror:4 row_mask:0xf bank_mask:0xf
  v_add_f32_dpp v16, v16, v16 row_ror:4 row_mask:0xf bank_mask:0xf
  v_add_f32_dpp v18, v18, v18 row_ror:4 row_mask:0xf bank_mask:0xf
  v_add_f32_dpp v20, v20, v20 row_ror:4 row_mask:0xf bank_mask:0xf
  v_add_f32_dpp v22, v22, v22 row_ror:4 row_mask:0xf bank_mask:0xf
  v_add_f32_dpp v24, v24, v24 row_ror:4 row_mask:0xf bank_mask:0xf
  v_add_f32_dpp v26, v26, v26 row_ror:4 row_mask:0xf bank_mask:0xf
  v_add_f32_dpp v28, v28, v28 row_ror:4 row_mask:0xf bank_mask:0xf
  v_add_f32_dpp v30, v30, v30 row_ror:4 row_mask:0xf bank_mask:0xf
  s_nop 1
  v_add_f32_dpp v33, v33, v33 row_ror:8 row_mask:0xf bank_mask:0xf
  v_add_f32_dpp v16, v16, v16 row_ror:8 row_mask:0xf bank_mask:0xf
  v_add_f32_dpp v18, v18, v18 row_ror:8 row_mask:0xf bank_mask:0xf
  v_add_f32_dpp v20, v20, v20 row_ror:8 row_mask:0xf bank_mask:0xf
  v_add_f32_dpp v22, v22, v22 row_ror:8 row_mask:0xf bank_mask:0xf
  v_add_f32_dpp v24, v24, v24 row_ror:8 row_mask:0xf bank_mask:0xf
  v_add_f32_dpp v26, v26, v26 row_ror:8 row_mask:0xf bank_mask:0xf
  v_add_f32_dpp v28, v28, v28 row_ror:8 row_mask:0xf bank_mask:0xf
  v_add_f32_dpp v30, v30, v30 row_ror:8 row_mask:0xf bank_mask:0xf
  v_mov_b32 v36, v33
  v_mov_b32 v37, v16
  v_mov_b32 v38, v18
  v_mov_b32 v39, v20
  v_mov_b32 v40, v22
  v_mov_b32 v41, v24
  v_mov_b32 v42, v26
  v_mov_b32 v43, v28
  v_mov_b32 v44, v30
  s_nop 1
  v_permlane16_swap_b32 v33, v36
  v_permlane16_swap_b32 v16, v37
  v_permlane16_swap_b32 v18, v38
  v_permlane16_swap_b32 v20, v39
  v_permlane16_swap_b32 v22, v40
  v_permlane16_swap_b32 v24, v41
  v_permlane16_swap_b32 v26, v42
  v_permlane16_swap_b32 v28, v43
  v_permlane16_swap_b32 v30, v44
  s_nop 1
  v_add_f32 v33, v33, v36
  v_add_f32 v16, v16, v37
  v_add_f32 v18, v18, v38
  v_add_f32 v20, v20, v39
  v_add_f32 v22, v22, v40
  v_add_f32 v24, v24, v41
  v_add_f32 v26, v26, v42
  v_add_f32 v28, v28, v43
  v_add_f32 v30, v30, v44
  v_mov_b32 v36, v33
  v_mov_b32 v37, v16
  v_mov_b32 v38, v18
  v_mov_b32 v39, v20
  v_mov_b32 v40, v22
  v_mov_b32 v41, v24
  v_mov_b32 v42, v26
  v_mov_b32 v43, v28
  v_mov_b32 v44, v30
  s_nop 1
  v_permlane32_swap_b32 v33, v36
  v_permlane32_swap_b32 v16, v37
  v_permlane32_swap_b32 v18, v38
  v_permlane32_swap_b32 v20, v39
  v_permlane32_swap_b32 v22, v40
  v_permlane32_swap_b32 v24, v41
  v_permlane32_swap_b32 v26, v42
  v_permlane32_swap_b32 v28, v43
  v_permlane32_swap_b32 v30, v44
  s_nop 1
  v_add_f32 v33, v33, v36
  v_add_f32 v16, v16, v37
  v_add_f32 v18, v18, v38
  v_add_f32 v20, v20, v39
  v_add_f32 v22, v22, v40
  v_add_f32 v24, v24, v41
  v_add_f32 v26, v26, v42
  v_add_f32 v28, v28, v43
  v_add_f32 v30, v30, v44
  v_rcp_f32 v33, v33
  s_nop 0
  v_mul_f32 v16, v16, v33
  v_mul_f32 v18, v18, v33
  v_mul_f32 v20, v20, v33
  v_mul_f32 v22, v22, v33
  v_mul_f32 v24, v24, v33
  v_mul_f32 v26, v26, v33
  v_mul_f32 v28, v28, v33
  v_mul_f32 v30, v30, v33
  v_cvt_pk_bf16_f32 v36, v16, v18
  v_cvt_pk_bf16_f32 v37, v20, v22
  v_cvt_pk_bf16_f32 v38, v24, v26
  v_cvt_pk_bf16_f32 v39, v28, v30
  s_lshl_b32 s75, s3, 6
  v_lshl_add_u32 v8, v5, 4, s75
  s_mov_b64 exec, 0xf
  ds_write_b128 v8, v[36:39] offset:0
  s_mov_b64 exec, -1
  s_waitcnt lgkmcnt(0)
  s_barrier
  s_cmp_ge_u32 s3, 4
  s_cbranch_scc1 T_F
  ds_read_b128 v[132:135], v11 offset:0
  ds_read_b128 v[136:139], v11 offset:64
  ds_read_b128 v[140:143], v11 offset:128
  ds_read_b128 v[144:147], v11 offset:192
  s_waitcnt lgkmcnt(0)
  v_mfma_f32_16x16x32_bf16 v[148:151], v[132:135], v[112:115], 0
  v_mfma_f32_16x16x32_bf16 v[148:151], v[136:139], v[116:119], v[148:151]
  v_mfma_f32_16x16x32_bf16 v[148:151], v[140:143], v[120:123], v[148:151]
  v_mfma_f32_16x16x32_bf16 v[148:151], v[144:147], v[124:127], v[148:151]
  v_cmp_eq_u32 vcc, 1, v12
  v_mov_b32 v153, s26
  s_nop 7
  s_nop 7
  v_cndmask_b32 v152, v148, v149, vcc
  s_mov_b64 exec, 0xffffffff
  buffer_store_dwordx2 v[152:153], v13, s[20:23], 0 offen sc1
  s_mov_b64 exec, -1
T_F:
  s_cmp_ge_u32 s2, 8
  s_cbranch_scc1 K_END
T_FIN:
  s_lshr_b32 s75, s3, 2
  s_lshl_b32 s75, s75, 9
  s_and_b32 s76, s2, 7
  s_lshl_b32 s76, s76, 6
  s_add_u32 s75, s75, s76
  s_and_b32 s76, s3, 3
  s_lshl_b32 s76, s76, 4
  s_add_u32 s75, s75, s76
  v_lshlrev_b32 v7, 1, v5
  v_add_u32 v7, s75, v7
  v_lshlrev_b32 v8, 1, v7
  buffer_load_dword v46, v8, s[28:31], 0 offen
  buffer_load_dword v47, v8, s[28:31], 0 offen offset:16
  v_lshlrev_b32 v10, 3, v7
  v_lshl_add_u32 v10, v6, 13, v10
  s_not_b32 s75, s26
  v_mov_b32 v16, 0
  v_mov_b32 v17, s75
  v_mov_b32 v18, 0
  v_mov_b32 v19, s75
  v_mov_b32 v20, 0
  v_mov_b32 v21, s75
  v_mov_b32 v22, 0
  v_mov_b32 v23, s75
  v_mov_b32 v24, 0
  v_mov_b32 v25, s75
  v_mov_b32 v26, 0
  v_mov_b32 v27, s75
  v_mov_b32 v28, 0
  v_mov_b32 v29, s75
  v_mov_b32 v30, 0
  v_mov_b32 v31, s75
  s_mov_b64 s[76:77], -1
  s_mov_b32 s78, 0xffffffff
  s_mov_b32 s79, 0xffff
  s_mov_b64 s[82:83], s[78:79]
  s_mov_b32 s72, 7340032
  s_mov_b32 s73, 7471104
  s_mov_b32 s74, 0x100000
T_G:
  s_mov_b64 exec, s[76:77]
  s_cbranch_execz T_G1
  buffer_load_dwordx4 v[16:19], v10, s[20:23], s72 offen offset:0 sc1
  buffer_load_dwordx4 v[20:23], v10, s[20:23], s72 offen offset:64 sc1
T_G1:
  s_mov_b64 exec, s[78:79]
  s_cbranch_execz T_G2
  buffer_load_dwordx4 v[24:27], v10, s[20:23], s73 offen offset:0 sc1
  buffer_load_dwordx4 v[28:31], v10, s[20:23], s73 offen offset:64 sc1
T_G2:
  s_mov_b64 exec, -1
  s_waitcnt vmcnt(0)
  s_sleep 1
  v_cmp_ne_u32 s[76:77], s26, v17
  v_cmp_ne_u32 vcc, s26, v19
  s_or_b64 s[76:77], s[76:77], vcc
  v_cmp_ne_u32 vcc, s26, v21
  s_or_b64 s[76:77], s[76:77], vcc
  v_cmp_ne_u32 vcc, s26, v23
  s_or_b64 s[76:77], s[76:77], vcc
  v_cmp_ne_u32 s[78:79], s26, v25
  v_cmp_ne_u32 vcc, s26, v27
  s_or_b64 s[78:79], s[78:79], vcc
  v_cmp_ne_u32 vcc, s26, v29
  s_or_b64 s[78:79], s[78:79], vcc
  v_cmp_ne_u32 vcc, s26, v31
  s_or_b64 s[78:79], s[78:79], vcc
  s_and_b64 s[78:79], s[78:79], s[82:83]
  s_or_b64 s[80:81], s[76:77], s[78:79]
  s_cmp_eq_u64 s[80:81], 0
  s_cbranch_scc1 T_GD
  s_sub_u32 s74, s74, 1
  s_cmp_lg_u32 s74, 0
  s_cbranch_scc1 T_G
T_GD:
  s_waitcnt vmcnt(0)
  v_add_f32 v40, v16, v24
  v_add_f32 v41, v18, v26
  v_add_f32 v42, v20, v28
  v_add_f32 v43, v22, v30
  s_nop 1
  v_add_f32_dpp v40, v40, v40 row_ror:4 row_mask:0xf bank_mask:0xf
  v_add_f32_dpp v41, v41, v41 row_ror:4 row_mask:0xf bank_mask:0xf
  v_add_f32_dpp v42, v42, v42 row_ror:4 row_mask:0xf bank_mask:0xf
  v_add_f32_dpp v43, v43, v43 row_ror:4 row_mask:0xf bank_mask:0xf
  s_nop 1
  v_add_f32_dpp v40, v40, v40 row_ror:8 row_mask:0xf bank_mask:0xf
  v_add_f32_dpp v41, v41, v41 row_ror:8 row_mask:0xf bank_mask:0xf
  v_add_f32_dpp v42, v42, v42 row_ror:8 row_mask:0xf bank_mask:0xf
  v_add_f32_dpp v43, v43, v43 row_ror:8 row_mask:0xf bank_mask:0xf
  v_mov_b32 v36, v40
  v_mov_b32 v37, v41
  v_mov_b32 v38, v42
  v_mov_b32 v39, v43
  s_nop 1
  v_permlane16_swap_b32 v40, v36
  v_permlane16_swap_b32 v41, v37
  v_permlane16_swap_b32 v42, v38
  v_permlane16_swap_b32 v43, v39
  s_nop 1
  v_add_f32 v40, v40, v36
  v_add_f32 v41, v41, v37
  v_add_f32 v42, v42, v38
  v_add_f32 v43, v43, v39
  v_mov_b32 v36, v40
  v_mov_b32 v37, v41
  v_mov_b32 v38, v42
  v_mov_b32 v39, v43
  s_nop 1
  v_permlane32_swap_b32 v40, v36
  v_permlane32_swap_b32 v41, v37
  v_permlane32_swap_b32 v42, v38
  v_permlane32_swap_b32 v43, v39
  s_nop 1
  v_add_f32 v40, v40, v36
  v_add_f32 v41, v41, v37
  v_add_f32 v42, v42, v38
  v_add_f32 v43, v43, v39
  v_cvt_pk_bf16_f32 v40, v40, v40
  v_lshlrev_b32 v40, 16, v40
  v_cvt_pk_bf16_f32 v41, v41, v41
  v_lshlrev_b32 v41, 16, v41
  v_cvt_pk_bf16_f32 v42, v42, v42
  v_lshlrev_b32 v42, 16, v42
  v_cvt_pk_bf16_f32 v43, v43, v43
  v_lshlrev_b32 v43, 16, v43
  v_mul_f32 v36, 0xbfb8aa3b, v40
  v_mul_f32 v37, 0xbfb8aa3b, v41
  v_mul_f32 v38, 0xbfb8aa3b, v42
  v_mul_f32 v39, 0xbfb8aa3b, v43
  v_exp_f32 v36, v36
  v_exp_f32 v37, v37
  v_exp_f32 v38, v38
  v_exp_f32 v39, v39
  s_nop 0
  v_add_f32 v36, 1.0, v36
  v_add_f32 v37, 1.0, v37
  v_add_f32 v38, 1.0, v38
  v_add_f32 v39, 1.0, v39
  v_rcp_f32 v36, v36
  v_rcp_f32 v37, v37
  v_rcp_f32 v38, v38
  v_rcp_f32 v39, v39
  s_nop 0
  v_mul_f32 v40, v36, v40
  v_mul_f32 v41, v37, v41
  v_mul_f32 v42, v38, v42
  v_mul_f32 v43, v39, v43
  v_cvt_pk_bf16_f32 v40, v40, v40
  v_lshlrev_b32 v40, 16, v40
  v_cvt_pk_bf16_f32 v41, v41, v41
  v_lshlrev_b32 v41, 16, v41
  v_cvt_pk_bf16_f32 v42, v42, v42
  v_lshlrev_b32 v42, 16, v42
  v_cvt_pk_bf16_f32 v43, v43, v43
  v_lshlrev_b32 v43, 16, v43
  s_not_b32 s75, s26
  v_mov_b32 v16, 0
  v_mov_b32 v17, s75
  v_mov_b32 v18, 0
  v_mov_b32 v19, s75
  v_mov_b32 v20, 0
  v_mov_b32 v21, s75
  v_mov_b32 v22, 0
  v_mov_b32 v23, s75
  v_mov_b32 v24, 0
  v_mov_b32 v25, s75
  v_mov_b32 v26, 0
  v_mov_b32 v27, s75
  v_mov_b32 v28, 0
  v_mov_b32 v29, s75
  v_mov_b32 v30, 0
  v_mov_b32 v31, s75
  s_mov_b64 s[76:77], -1
  s_mov_b32 s78, 0xffffffff
  s_mov_b32 s79, 0xffffffff
  s_mov_b64 s[82:83], s[78:79]
  s_mov_b32 s72, 6356992
  s_mov_b32 s73, 6488064
  s_mov_b32 s74, 0x100000
T_S:
  s_mov_b64 exec, s[76:77]
  s_cbranch_execz T_S1
  buffer_load_dwordx4 v[16:19], v10, s[20:23], s72 offen offset:0 sc1
  buffer_load_dwordx4 v[20:23], v10, s[20:23], s72 offen offset:64 sc1
T_S1:
  s_mov_b64 exec, s[78:79]
  s_cbranch_execz T_S2
  buffer_load_dwordx4 v[24:27], v10, s[20:23], s73 offen offset:0 sc1
  buffer_load_dwordx4 v[28:31], v10, s[20:23], s73 offen offset:64 sc1
T_S2:
  s_mov_b64 exec, -1
  s_waitcnt vmcnt(0)
  s_sleep 1
  v_cmp_ne_u32 s[76:77], s26, v17
  v_cmp_ne_u32 vcc, s26, v19
  s_or_b64 s[76:77], s[76:77], vcc
  v_cmp_ne_u32 vcc, s26, v21
  s_or_b64 s[76:77], s[76:77], vcc
  v_cmp_ne_u32 vcc, s26, v23
  s_or_b64 s[76:77], s[76:77], vcc
  v_cmp_ne_u32 s[78:79], s26, v25
  v_cmp_ne_u32 vcc, s26, v27
  s_or_b64 s[78:79], s[78:79], vcc
  v_cmp_ne_u32 vcc, s26, v29
  s_or_b64 s[78:79], s[78:79], vcc
  v_cmp_ne_u32 vcc, s26, v31
  s_or_b64 s[78:79], s[78:79], vcc
  s_and_b64 s[78:79], s[78:79], s[82:83]
  s_or_b64 s[80:81], s[76:77], s[78:79]
  s_cmp_eq_u64 s[80:81], 0
  s_cbranch_scc1 T_SD
  s_sub_u32 s74, s74, 1
  s_cmp_lg_u32 s74, 0
  s_cbranch_scc1 T_S
T_SD:
  s_waitcnt vmcnt(0)
  v_add_f32 v48, v16, v24
  v_add_f32 v49, v18, v26
  v_add_f32 v50, v20, v28
  v_add_f32 v51, v22, v30
  s_nop 1
  v_add_f32_dpp v48, v48, v48 row_ror:4 row_mask:0xf bank_mask:0xf
  v_add_f32_dpp v49, v49, v49 row_ror:4 row_mask:0xf bank_mask:0xf
  v_add_f32_dpp v50, v50, v50 row_ror:4 row_mask:0xf bank_mask:0xf
  v_add_f32_dpp v51, v51, v51 row_ror:4 row_mask:0xf bank_mask:0xf
  s_nop 1
  v_add_f32_dpp v48, v48, v48 row_ror:8 row_mask:0xf bank_mask:0xf
  v_add_f32_dpp v49, v49, v49 row_ror:8 row_mask:0xf bank_mask:0xf
  v_add_f32_dpp v50, v50, v50 row_ror:8 row_mask:0xf bank_mask:0xf
  v_add_f32_dpp v51, v51, v51 row_ror:8 row_mask:0xf bank_mask:0xf
  v_mov_b32 v36, v48
  v_mov_b32 v37, v49
  v_mov_b32 v38, v50
  v_mov_b32 v39, v51
  s_nop 1
  v_permlane16_swap_b32 v48, v36
  v_permlane16_swap_b32 v49, v37
  v_permlane16_swap_b32 v50, v38
  v_permlane16_swap_b32 v51, v39
  s_nop 1
  v_add_f32 v48, v48, v36
  v_add_f32 v49, v49, v37
  v_add_f32 v50, v50, v38
  v_add_f32 v51, v51, v39
  v_mov_b32 v36, v48
  v_mov_b32 v37, v49
  v_mov_b32 v38, v50
  v_mov_b32 v39, v51
  s_nop 1
  v_permlane32_swap_b32 v48, v36
  v_permlane32_swap_b32 v49, v37
  v_permlane32_swap_b32 v50, v38
  v_permlane32_swap_b32 v51, v39
  s_nop 1
  v_add_f32 v48, v48, v36
  v_add_f32 v49, v49, v37
  v_add_f32 v50, v50, v38
  v_add_f32 v51, v51, v39
  v_cvt_pk_bf16_f32 v48, v48, v48
  v_lshlrev_b32 v48, 16, v48
  v_cvt_pk_bf16_f32 v49, v49, v49
  v_lshlrev_b32 v49, 16, v49
  v_cvt_pk_bf16_f32 v50, v50, v50
  v_lshlrev_b32 v50, 16, v50
  v_cvt_pk_bf16_f32 v51, v51, v51
  v_lshlrev_b32 v51, 16, v51
  v_mul_f32 v48, v48, v40
  v_mul_f32 v49, v49, v41
  v_mul_f32 v50, v50, v42
  v_mul_f32 v51, v51, v43
  v_cvt_pk_bf16_f32 v48, v48, v48
  v_lshlrev_b32 v48, 16, v48
  v_cvt_pk_bf16_f32 v49, v49, v49
  v_lshlrev_b32 v49, 16, v49
  v_cvt_pk_bf16_f32 v50, v50, v50
  v_lshlrev_b32 v50, 16, v50
  v_cvt_pk_bf16_f32 v51, v51, v51
  v_lshlrev_b32 v51, 16, v51
  v_lshlrev_b32 v36, 16, v46
  v_and_b32 v37, 0xffff0000, v46
  v_add_f32 v48, v48, v36
  v_add_f32 v49, v49, v37
  v_cvt_pk_bf16_f32 v48, v48, v49
  v_lshlrev_b32 v36, 16, v47
  v_and_b32 v37, 0xffff0000, v47
  v_add_f32 v50, v50, v36
  v_add_f32 v51, v51, v37
  v_cvt_pk_bf16_f32 v50, v50, v51
  s_mov_b64 exec, 0xf
  buffer_store_dword v48, v8, s[32:35], 0 offen
  buffer_store_dword v50, v8, s[32:35], 0 offen offset:16
  s_or_b32 s75, s2, s3
  s_cmp_lg_u32 s75, 0
  s_cbranch_scc1 K_END
  s_mov_b64 exec, 1
  v_mov_b32 v5, 2162688
  v_mov_b32 v6, s26
  buffer_store_dword v6, v5, s[20:23], 0 offen
K_END:
  s_endpgm
.section .rodata,"a"
.p2align 6
.amdhsa_kernel recurrent_scan__gqa_block_cached__dense_activation_relu__decode_kernel
  .amdhsa_next_free_vgpr 256
  .amdhsa_next_free_sgpr 102
  .amdhsa_accum_offset 256
  .amdhsa_group_segment_fixed_size 0
  .amdhsa_kernarg_size 88
  .amdhsa_user_sgpr_count 2
  .amdhsa_user_sgpr_kernarg_segment_ptr 1
  .amdhsa_system_sgpr_workgroup_id_x 1
.end_amdhsa_kernel
```
